```python
import torch

def _softmax(x, axis=-1):
    return torch.softmax(x, dim=axis)
def _gelu(x):
    return torch.nn.functional.gelu(x, approximate="tanh")
def _silu(x):
    return torch.nn.functional.silu(x)
def _sigmoid(x):
    return torch.sigmoid(x)
def _layernorm(x, axis=-1, eps=1e-5):
    m = x.mean(dim=axis, keepdim=True)
    v = x.var(dim=axis, keepdim=True, unbiased=False)
    return (x - m) / torch.sqrt(v + eps)
def _scatter_add(tgt, idx, src, axis=0):
    return tgt.clone().index_add_(axis, idx, src)
def _segment_sum(src, seg, n):
    out = torch.zeros((n,) + src.shape[1:], dtype=src.dtype)
    return out.index_add_(0, seg, src)
def _pad(x, pw):
    flat = tuple(v for pair in reversed(pw) for v in pair)
    return torch.nn.functional.pad(x, flat)

kernel_name = 'sequential_preLN__sliding_local_dilated__glu_gated_reglu__prompt'

def setup_inputs():

    _w = (lambda a: (lambda t: t.to(torch.bfloat16) if t.is_floating_point() else t)(torch.as_tensor(a)))
    def _A_setup():
        B, S, D = 1, 2048, 448
        return {
            "x": _w((lambda *s: torch.randn(*s, dtype=torch.bfloat16) * 0.05)(B, S, D)),
            "wqkv": _w((lambda *s: torch.randn(*s, dtype=torch.bfloat16) * 0.05)(D, 3 * D)),
            "wo": _w((lambda *s: torch.randn(*s, dtype=torch.bfloat16) * 0.05)(D, D)),
        }
    _A_in = _A_setup()

    def _B_setup():
        B, S, D, F = 1, 2048, 448, 1792
        return {
            "x": _w((lambda *s: torch.randn(*s, dtype=torch.bfloat16) * 0.05)(B, S, D)),
            "W_gate": _w((lambda *s: torch.randn(*s, dtype=torch.bfloat16) * 0.8)(D, F) * (2.0 / D) ** 0.5),
            "W_up": _w((lambda *s: torch.randn(*s, dtype=torch.bfloat16) * 0.8)(D, F) * (2.0 / D) ** 0.5),
            "W_down": _w((lambda *s: torch.randn(*s, dtype=torch.bfloat16) * 0.8)(F, D) * (1.0 / F) ** 0.5),
        }
    _B_in = _B_setup()

    return {
        "A_x": _A_in["x"],
        "A_wqkv": _A_in["wqkv"],
        "A_wo": _A_in["wo"],
        "B_x": _B_in["x"],
        "B_W_gate": _B_in["W_gate"],
        "B_W_up": _B_in["W_up"],
        "B_W_down": _B_in["W_down"],
    }

def reference(A_x, A_wqkv, A_wo, B_x, B_W_gate, B_W_up, B_W_down):
    def _A_ref(x, wqkv, wo):
        B, S, D = x.shape
        H = 16; Dh = D // H
        W, dil = 8, 2
        qkv = (lambda x, *d: x.permute(*d))((x @ wqkv).reshape(B, S, 3, H, Dh), 2, 0, 3, 1, 4)
        q, k, v = qkv[0], qkv[1], qkv[2]
        scale = Dh ** -0.5
        pos = torch.arange(S)
        off = torch.arange(W) * dil
        idx = pos[:, None] - off[None, :]
        mask = idx >= 0
        idx_c = torch.where(mask, idx, 0).reshape(-1)
        kg = k[:, :, idx_c, :].reshape(B, H, S, W, Dh)
        vg = v[:, :, idx_c, :].reshape(B, H, S, W, Dh)
        logits = torch.einsum("bhsd,bhswd->bhsw", q, kg) * scale
        logits = torch.where(mask[None, None, :, :], logits, -1e9)
        attn = _softmax(logits, axis=-1)
        o = torch.einsum("bhsw,bhswd->bhsd", attn, vg)
        return (lambda x, *d: x.permute(*d))(o, 0, 2, 1, 3).reshape(B, S, D) @ wo

    def _B_ref(x, W_gate, W_up, W_down):
        gate = torch.einsum("bsd,df->bsf", x, W_gate)
        up = torch.einsum("bsd,df->bsf", x, W_up)
        gate = gate * (lambda x, dt: x.to(dt))(gate > 0, gate.dtype)
        h = gate * up
        return torch.einsum("bsf,fd->bsd", h, W_down)

    x = A_x
    h = x + _A_ref(_layernorm(x, axis=-1), A_wqkv, A_wo)
    h2 = h + _B_ref(_layernorm(h, axis=-1), B_W_gate, B_W_up, B_W_down)
    return h2
```

```asm
; @launch grid=(256,1,1) block=(512,1,1) lds=163840
.amdgcn_target "amdgcn-amd-amdhsa--gfx950"
.text
.globl sequential_preLN__sliding_local_dilated__glu_gated_reglu__prompt_kernel
.p2align 12
.p2align 8
.type sequential_preLN__sliding_local_dilated__glu_gated_reglu__prompt_kernel,@function
sequential_preLN__sliding_local_dilated__glu_gated_reglu__prompt_kernel:
    s_load_dwordx2 s[8:9], s[0:1], 0
    s_load_dwordx2 s[12:13], s[0:1], 8
    s_load_dwordx2 s[16:17], s[0:1], 16
    s_load_dwordx2 s[20:21], s[0:1], 32
    s_load_dwordx2 s[24:25], s[0:1], 40
    s_load_dwordx2 s[28:29], s[0:1], 48
    s_load_dwordx2 s[32:33], s[0:1], 56
    s_load_dwordx2 s[40:41], s[0:1], 64
    s_load_dwordx2 s[36:37], s[0:1], 72
    s_cmp_ge_u32 s2, 256
    s_cbranch_scc1 EXIT
    v_lshrrev_b32 v2, 6, v0
    v_and_b32 v1, 63, v0
    v_readfirstlane_b32 s5, v2
    s_and_b32 s45, s2, 7
    s_lshr_b32 s46, s2, 3
    v_lshlrev_b32 v2, 4, v1
    s_and_b32 s44, s5, 3
    s_mul_i32 s52, s46, 37
    s_lshr_b32 s52, s52, 8
    s_mul_i32 s3, s52, 7
    s_sub_u32 s53, s46, s3
    s_cmp_ge_u32 s46, 28
    s_cselect_b32 s49, 7, s53
    s_cselect_b32 s3, s53, s52
    s_lshl_b32 s3, s3, 2
    s_lshr_b32 s4, s45, 2
    s_lshl_b32 s4, s4, 4
    s_add_u32 s3, s3, s4
    s_and_b32 s4, s45, 3
    s_add_u32 s3, s3, s4
    s_lshl_b32 s48, s3, 6
    s_lshl_b32 s54, s3, 1
    s_lshr_b32 s50, s45, 2
    s_lshl_b32 s50, s50, 2
    s_add_u32 s50, s50, s52
    s_and_b32 s51, s45, 3
    s_mul_i32 s51, s51, 7
    s_add_u32 s51, s51, s53
    s_and_b32 s52, s45, 3
    s_mov_b32 s10, 1835008
    s_mov_b32 s11, 0x20000
    s_mov_b32 s14, 1204224
    s_mov_b32 s15, 0x20000
    s_mov_b32 s18, 401408
    s_mov_b32 s19, 0x20000
    s_mov_b32 s22, 1605632
    s_mov_b32 s23, 0x20000
    s_mov_b32 s26, 1605632
    s_mov_b32 s27, 0x20000
    s_mov_b32 s30, 1605632
    s_mov_b32 s31, 0x20000
    s_mov_b32 s34, 1835008
    s_mov_b32 s35, 0x20000
    s_mov_b32 s42, 256
    s_mov_b32 s43, 0x20000
    s_mov_b32 s38, 16777216
    s_mov_b32 s39, 0x20000
    s_mov_b32 s0, 1
    s_cmp_ge_u32 s5, 4
    s_cbranch_scc0 ROLE_X
    s_cmp_eq_u32 s45, 7
    s_cselect_b32 s55, 0, s45
    s_and_b32 s55, s55, 7
    s_lshl_b32 s56, s55, 7
    s_mul_i32 s57, s55, 172032
    s_mul_i32 s3, s49, 112
    s_add_u32 s57, s57, s3
    s_lshl_b32 s58, s44, 10
    s_lshl_b32 s59, s44, 11
    v_lshrrev_b32 v3, 3, v1
    v_and_b32 v4, 7, v1
    v_lshrrev_b32 v5, 1, v3
    s_and_b32 s3, s44, 1
    s_lshl_b32 s3, s3, 2
    v_or_b32 v5, s3, v5
    v_xor_b32 v5, v5, v4
    v_lshlrev_b32 v5, 4, v5
    s_lshl_b32 s3, s44, 3
    s_add_u32 s3, s3, s48
    s_sub_u32 s3, s3, 16
    v_add_u32 v6, s3, v3
    v_add_u32 v36, 0, v6
    v_max_i32 v36, 0, v36
    v_mul_u32_u24 v36, 896, v36
    v_add_u32 v36, v36, v5
    v_add_u32 v37, 32, v6
    v_max_i32 v37, 0, v37
    v_mul_u32_u24 v37, 896, v37
    v_add_u32 v37, v37, v5
    v_add_u32 v38, 64, v6
    v_max_i32 v38, 0, v38
    v_mul_u32_u24 v38, 896, v38
    v_add_u32 v38, v38, v5
    v_and_b32 v5, 2, v3
    v_xor_b32 v5, v5, v4
    v_lshlrev_b32 v5, 4, v5
    s_and_b32 s3, s44, 1
    s_lshl_b32 s3, s3, 6
    v_xor_b32 v5, s3, v5
    s_lshl_b32 s3, s44, 3
    v_add_u32 v6, s3, v3
    v_mul_u32_u24 v6, 2688, v6
    v_min_u32 v5, 96, v5
    v_add_u32 v30, v6, v5
    v_and_b32 v5, 2, v3
    v_xor_b32 v5, v5, v4
    v_mul_u32_u24 v28, 3584, v3
    v_lshl_add_u32 v28, v5, 4, v28
    s_and_b32 s3, s44, 1
    s_lshl_b32 s3, s3, 6
    v_xor_b32 v28, s3, v28
    v_add_u32 v31, 86016, v30
    v_add_u32 v32, 896, v30
    v_add_u32 v33, 896, v31
    v_add_u32 v34, 1792, v30
    v_add_u32 v35, 1792, v31
    v_and_b32 v5, 2, v3
    v_lshlrev_b32 v5, 1, v5
    v_xor_b32 v4, v4, v5
    v_mul_u32_u24 v3, 896, v3
    v_lshl_add_u32 v10, v4, 4, v3
    s_waitcnt lgkmcnt(0)
    s_add_u32 m0, s58, 126976
    s_nop 0
    buffer_load_dwordx4 v36, s[8:11], s56 offen   lds
    s_add_u32 m0, s58, 131072
    s_nop 0
    buffer_load_dwordx4 v37, s[8:11], s56 offen   lds
    s_cmp_ge_u32 s44, 2
    s_cbranch_scc1 P1skip_1
    s_add_u32 m0, s58, 135168
    s_nop 0
    buffer_load_dwordx4 v38, s[8:11], s56 offen   lds
P1skip_1:
    s_add_u32 m0, s58, 137216
    s_nop 0
    buffer_load_dwordx4 v30, s[12:15], s57 offen   lds
    s_add_u32 m0, s58, 145408
    s_nop 0
    buffer_load_dwordx4 v32, s[12:15], s57 offen   lds
    s_add_u32 m0, s58, 153600
    s_nop 0
    buffer_load_dwordx4 v34, s[12:15], s57 offen   lds
    s_add_u32 m0, s58, 141312
    s_nop 0
    buffer_load_dwordx4 v31, s[12:15], s57 offen   lds
    s_add_u32 m0, s58, 149504
    s_nop 0
    buffer_load_dwordx4 v33, s[12:15], s57 offen   lds
    s_add_u32 m0, s58, 157696
    s_nop 0
    buffer_load_dwordx4 v35, s[12:15], s57 offen   lds
    s_add_u32 s55, s55, 1
    s_add_u32 s56, s56, 128
    s_add_u32 s57, s57, 172032
    s_cmp_eq_u32 s55, 7
    s_cselect_b32 s3, 896, 0
    s_sub_u32 s56, s56, s3
    s_cmp_eq_u32 s55, 7
    s_cselect_b32 s3, 1204224, 0
    s_sub_u32 s57, s57, s3
    s_add_u32 m0, s58, 57344
    s_nop 0
    buffer_load_dwordx4 v36, s[8:11], s56 offen   lds
    s_add_u32 m0, s58, 61440
    s_nop 0
    buffer_load_dwordx4 v37, s[8:11], s56 offen   lds
    s_cmp_ge_u32 s44, 2
    s_cbranch_scc1 P1skip_2
    s_add_u32 m0, s58, 65536
    s_nop 0
    buffer_load_dwordx4 v38, s[8:11], s56 offen   lds
P1skip_2:
    s_add_u32 m0, s58, 67584
    s_nop 0
    buffer_load_dwordx4 v30, s[12:15], s57 offen   lds
    s_add_u32 m0, s58, 75776
    s_nop 0
    buffer_load_dwordx4 v32, s[12:15], s57 offen   lds
    s_add_u32 m0, s58, 83968
    s_nop 0
    buffer_load_dwordx4 v34, s[12:15], s57 offen   lds
    s_add_u32 m0, s58, 71680
    s_nop 0
    buffer_load_dwordx4 v31, s[12:15], s57 offen   lds
    s_add_u32 m0, s58, 79872
    s_nop 0
    buffer_load_dwordx4 v33, s[12:15], s57 offen   lds
    s_add_u32 m0, s58, 88064
    s_nop 0
    buffer_load_dwordx4 v35, s[12:15], s57 offen   lds
    s_add_u32 s55, s55, 1
    s_add_u32 s56, s56, 128
    s_add_u32 s57, s57, 172032
    s_cmp_eq_u32 s55, 7
    s_cselect_b32 s3, 896, 0
    s_sub_u32 s56, s56, s3
    s_cmp_eq_u32 s55, 7
    s_cselect_b32 s3, 1204224, 0
    s_sub_u32 s57, s57, s3
    s_waitcnt vmcnt(8)
    s_barrier
    s_add_u32 m0, s58, 92160
    s_nop 0
    buffer_load_dwordx4 v36, s[8:11], s56 offen   lds
    s_add_u32 m0, s58, 96256
    s_nop 0
    buffer_load_dwordx4 v37, s[8:11], s56 offen   lds
    s_cmp_ge_u32 s44, 2
    s_cbranch_scc1 P1skip_3
    s_add_u32 m0, s58, 100352
    s_nop 0
    buffer_load_dwordx4 v38, s[8:11], s56 offen   lds
P1skip_3:
    s_add_u32 m0, s58, 102400
    s_nop 0
    buffer_load_dwordx4 v30, s[12:15], s57 offen   lds
    s_add_u32 m0, s58, 110592
    s_nop 0
    buffer_load_dwordx4 v32, s[12:15], s57 offen   lds
    s_add_u32 m0, s58, 118784
    s_nop 0
    buffer_load_dwordx4 v34, s[12:15], s57 offen   lds
    s_add_u32 m0, s58, 106496
    s_nop 0
    buffer_load_dwordx4 v31, s[12:15], s57 offen   lds
    s_add_u32 m0, s58, 114688
    s_nop 0
    buffer_load_dwordx4 v33, s[12:15], s57 offen   lds
    s_add_u32 m0, s58, 122880
    s_nop 0
    buffer_load_dwordx4 v35, s[12:15], s57 offen   lds
    s_add_u32 s55, s55, 1
    s_add_u32 s56, s56, 128
    s_add_u32 s57, s57, 172032
    s_cmp_eq_u32 s55, 7
    s_cselect_b32 s3, 896, 0
    s_sub_u32 s56, s56, s3
    s_cmp_eq_u32 s55, 7
    s_cselect_b32 s3, 1204224, 0
    s_sub_u32 s57, s57, s3
    s_lshr_b32 s3, s44, 1
    s_add_u32 s60, s54, s3
    s_and_b32 s3, s44, 1
    s_lshl_b32 s61, s53, 1
    s_add_u32 s61, s61, s3
    s_mul_i32 s62, s44, 7168
    s_lshl_b32 s3, s53, 7
    s_add_u32 s62, s62, s3
    s_mul_i32 s63, s44, 28672
    s_lshl_b32 s3, s51, 7
    s_add_u32 s63, s63, s3
    v_and_b32 v3, 31, v1
    v_lshrrev_b32 v4, 5, v1
    v_bfe_u32 v5, v1, 1, 3
    s_and_b32 s3, s44, 1
    s_lshl_b32 s3, s3, 2
    v_or_b32 v41, s3, v4
    v_xor_b32 v41, v41, v5
    v_lshlrev_b32 v41, 4, v41
    v_lshl_add_u32 v41, v3, 7, v41
    s_lshr_b32 s3, s44, 1
    s_lshl_b32 s3, s3, 12
    s_add_u32 s3, s3, 2048
    v_add_u32 v41, s3, v41
    s_cmp_eq_u32 s45, 7
    s_cselect_b32 s3, 0, s45
    s_add_u32 s66, s53, 7
    s_sub_u32 s66, s66, s3
    s_cmp_ge_u32 s66, 7
    s_cselect_b32 s3, 7, 0
    s_sub_u32 s66, s66, s3
    v_mul_u32_u24 v43, 1792, v4
    v_lshl_add_u32 v43, v3, 2, v43
    v_lshrrev_b32 v5, 4, v3
    v_lshlrev_b32 v5, 14, v5
    v_and_b32 v3, 15, v3
    v_lshl_add_u32 v5, v3, 4, v5
    v_lshl_add_u32 v5, v4, 8, v5
    s_lshr_b32 s3, s44, 1
    s_lshl_b32 s3, s3, 15
    s_add_u32 s3, s3, 57344
    v_add_u32 v40, s3, v5
    v_lshlrev_b32 v42, 7, v1
    s_and_b32 s65, s44, 1
    s_lshl_b32 s65, s65, 6
    v_bfe_u32 v3, v1, 2, 2
    v_lshrrev_b32 v4, 5, v1
    v_lshl_add_u32 v5, v4, 2, v3
    v_lshlrev_b32 v5, 7, v5
    v_and_b32 v3, 2, v3
    v_lshlrev_b32 v3, 5, v3
    v_and_b32 v4, 16, v1
    v_lshlrev_b32 v4, 1, v4
    v_and_b32 v6, 1, v1
    v_lshl_or_b32 v4, v6, 4, v4
    v_and_b32 v6, 2, v1
    v_lshl_or_b32 v4, v6, 2, v4
    v_or_b32 v4, s65, v4
    v_xor_b32 v4, v4, v3
    v_add3_u32 v39, v4, v5, 0
    s_waitcnt lgkmcnt(0)
    s_cmp_lg_u32 s66, 0
    s_cbranch_scc1 RS0
    v_add_u32 v41, 126976, v41
    ds_read_b128 v[44:47], v41
    v_xor_b32 v41, 32, v41
    ds_read_b128 v[48:51], v41
    s_waitcnt lgkmcnt(0)
RS0:
    s_waitcnt vmcnt(8)
    s_barrier
    s_add_u32 m0, s58, 126976
    s_nop 0
    buffer_load_dwordx4 v36, s[8:11], s56 offen   lds
    s_add_u32 m0, s58, 131072
    s_nop 0
    buffer_load_dwordx4 v37, s[8:11], s56 offen   lds
    s_cmp_ge_u32 s44, 2
    s_cbranch_scc1 P1skip_4
    s_add_u32 m0, s58, 135168
    s_nop 0
    buffer_load_dwordx4 v38, s[8:11], s56 offen   lds
P1skip_4:
    s_add_u32 m0, s58, 137216
    s_nop 0
    buffer_load_dwordx4 v30, s[12:15], s57 offen   lds
    s_add_u32 m0, s58, 145408
    s_nop 0
    buffer_load_dwordx4 v32, s[12:15], s57 offen   lds
    s_add_u32 m0, s58, 153600
    s_nop 0
    buffer_load_dwordx4 v34, s[12:15], s57 offen   lds
    s_add_u32 m0, s58, 141312
    s_nop 0
    buffer_load_dwordx4 v31, s[12:15], s57 offen   lds
    s_add_u32 m0, s58, 149504
    s_nop 0
    buffer_load_dwordx4 v33, s[12:15], s57 offen   lds
    s_add_u32 m0, s58, 157696
    s_nop 0
    buffer_load_dwordx4 v35, s[12:15], s57 offen   lds
    s_add_u32 s55, s55, 1
    s_add_u32 s56, s56, 128
    s_add_u32 s57, s57, 172032
    s_cmp_eq_u32 s55, 7
    s_cselect_b32 s3, 896, 0
    s_sub_u32 s56, s56, s3
    s_cmp_eq_u32 s55, 7
    s_cselect_b32 s3, 1204224, 0
    s_sub_u32 s57, s57, s3
    s_cmp_lg_u32 s66, 1
    s_cbranch_scc1 RS1
    v_add_u32 v41, 57344, v41
    ds_read_b128 v[44:47], v41
    v_xor_b32 v41, 32, v41
    ds_read_b128 v[48:51], v41
    s_waitcnt lgkmcnt(0)
RS1:
    s_waitcnt vmcnt(8)
    s_barrier
    s_add_u32 m0, s58, 57344
    s_nop 0
    buffer_load_dwordx4 v36, s[8:11], s56 offen   lds
    s_add_u32 m0, s58, 61440
    s_nop 0
    buffer_load_dwordx4 v37, s[8:11], s56 offen   lds
    s_cmp_ge_u32 s44, 2
    s_cbranch_scc1 P1skip_5
    s_add_u32 m0, s58, 65536
    s_nop 0
    buffer_load_dwordx4 v38, s[8:11], s56 offen   lds
P1skip_5:
    s_add_u32 m0, s58, 67584
    s_nop 0
    buffer_load_dwordx4 v30, s[12:15], s57 offen   lds
    s_add_u32 m0, s58, 75776
    s_nop 0
    buffer_load_dwordx4 v32, s[12:15], s57 offen   lds
    s_add_u32 m0, s58, 83968
    s_nop 0
    buffer_load_dwordx4 v34, s[12:15], s57 offen   lds
    s_add_u32 m0, s58, 71680
    s_nop 0
    buffer_load_dwordx4 v31, s[12:15], s57 offen   lds
    s_add_u32 m0, s58, 79872
    s_nop 0
    buffer_load_dwordx4 v33, s[12:15], s57 offen   lds
    s_add_u32 m0, s58, 88064
    s_nop 0
    buffer_load_dwordx4 v35, s[12:15], s57 offen   lds
    s_add_u32 s55, s55, 1
    s_add_u32 s56, s56, 128
    s_add_u32 s57, s57, 172032
    s_cmp_eq_u32 s55, 7
    s_cselect_b32 s3, 896, 0
    s_sub_u32 s56, s56, s3
    s_cmp_eq_u32 s55, 7
    s_cselect_b32 s3, 1204224, 0
    s_sub_u32 s57, s57, s3
    s_cmp_lg_u32 s66, 2
    s_cbranch_scc1 RS2
    v_add_u32 v41, 92160, v41
    ds_read_b128 v[44:47], v41
    v_xor_b32 v41, 32, v41
    ds_read_b128 v[48:51], v41
    s_waitcnt lgkmcnt(0)
RS2:
    s_waitcnt vmcnt(8)
    s_barrier
    v_mov_b32 v5, 0
    buffer_load_dwordx2 v[8:9], v5, s[40:43], 0 offen sc1
    s_add_u32 m0, s58, 92160
    s_nop 0
    buffer_load_dwordx4 v36, s[8:11], s56 offen   lds
    s_add_u32 m0, s58, 96256
    s_nop 0
    buffer_load_dwordx4 v37, s[8:11], s56 offen   lds
    s_cmp_ge_u32 s44, 2
    s_cbranch_scc1 P1skip_6
    s_add_u32 m0, s58, 100352
    s_nop 0
    buffer_load_dwordx4 v38, s[8:11], s56 offen   lds
P1skip_6:
    s_add_u32 m0, s58, 102400
    s_nop 0
    buffer_load_dwordx4 v30, s[12:15], s57 offen   lds
    s_add_u32 m0, s58, 110592
    s_nop 0
    buffer_load_dwordx4 v32, s[12:15], s57 offen   lds
    s_add_u32 m0, s58, 118784
    s_nop 0
    buffer_load_dwordx4 v34, s[12:15], s57 offen   lds
    s_add_u32 m0, s58, 106496
    s_nop 0
    buffer_load_dwordx4 v31, s[12:15], s57 offen   lds
    s_add_u32 m0, s58, 114688
    s_nop 0
    buffer_load_dwordx4 v33, s[12:15], s57 offen   lds
    s_add_u32 m0, s58, 122880
    s_nop 0
    buffer_load_dwordx4 v35, s[12:15], s57 offen   lds
    s_add_u32 s55, s55, 1
    s_add_u32 s56, s56, 128
    s_add_u32 s57, s57, 172032
    s_cmp_eq_u32 s55, 7
    s_cselect_b32 s3, 896, 0
    s_sub_u32 s56, s56, s3
    s_cmp_eq_u32 s55, 7
    s_cselect_b32 s3, 1204224, 0
    s_sub_u32 s57, s57, s3
    s_cmp_lg_u32 s66, 3
    s_cbranch_scc1 RS3
    v_add_u32 v41, 126976, v41
    ds_read_b128 v[44:47], v41
    v_xor_b32 v41, 32, v41
    ds_read_b128 v[48:51], v41
    s_waitcnt lgkmcnt(0)
RS3:
    s_waitcnt vmcnt(9)
    s_barrier
    s_add_u32 m0, s58, 126976
    s_nop 0
    buffer_load_dwordx4 v36, s[8:11], s56 offen   lds
    s_add_u32 m0, s58, 131072
    s_nop 0
    buffer_load_dwordx4 v37, s[8:11], s56 offen   lds
    s_cmp_ge_u32 s44, 2
    s_cbranch_scc1 P1skip_7
    s_add_u32 m0, s58, 135168
    s_nop 0
    buffer_load_dwordx4 v38, s[8:11], s56 offen   lds
P1skip_7:
    s_add_u32 m0, s58, 137216
    s_nop 0
    buffer_load_dwordx4 v30, s[12:15], s57 offen   lds
    s_add_u32 m0, s58, 145408
    s_nop 0
    buffer_load_dwordx4 v32, s[12:15], s57 offen   lds
    s_add_u32 m0, s58, 153600
    s_nop 0
    buffer_load_dwordx4 v34, s[12:15], s57 offen   lds
    s_add_u32 m0, s58, 141312
    s_nop 0
    buffer_load_dwordx4 v31, s[12:15], s57 offen   lds
    s_add_u32 m0, s58, 149504
    s_nop 0
    buffer_load_dwordx4 v33, s[12:15], s57 offen   lds
    s_add_u32 m0, s58, 157696
    s_nop 0
    buffer_load_dwordx4 v35, s[12:15], s57 offen   lds
    s_add_u32 s55, s55, 1
    s_add_u32 s56, s56, 128
    s_add_u32 s57, s57, 172032
    s_cmp_eq_u32 s55, 7
    s_cselect_b32 s3, 896, 0
    s_sub_u32 s56, s56, s3
    s_cmp_eq_u32 s55, 7
    s_cselect_b32 s3, 1204224, 0
    s_sub_u32 s57, s57, s3
    s_cmp_lg_u32 s66, 4
    s_cbranch_scc1 RS4
    v_add_u32 v41, 57344, v41
    ds_read_b128 v[44:47], v41
    v_xor_b32 v41, 32, v41
    ds_read_b128 v[48:51], v41
    s_waitcnt lgkmcnt(0)
RS4:
    s_waitcnt vmcnt(8)
    s_branch PG_8
.p2align 12
STUB_y1:
    s_setpc_b64 s[6:7]
    s_nop 0
PG_8:
    s_mov_b32 s5, 0
    v_readfirstlane_b32 s7, v9
    s_nop 0
    s_cmp_lg_u32 s7, 0
    s_cbranch_scc1 NPD_10
NP_9:
    buffer_load_dwordx2 v[8:9], v5, s[40:43], 0 offen sc1
    s_waitcnt vmcnt(0)
    v_readfirstlane_b32 s7, v9
    s_add_u32 s5, s5, 1
    s_cmp_gt_u32 s5, 40000
    s_cbranch_scc1 NPD_10
    s_cmp_eq_u32 s7, 0
    s_cbranch_scc1 NP_9
NPD_10:
    v_readfirstlane_b32 s47, v8
    s_cmp_lg_u32 s44, 3
    s_cbranch_scc1 NPS
    s_sub_u32 s68, s47, 4
    s_mov_b32 s69, s68
    s_mov_b32 s70, s68
    s_mov_b32 s71, s68
    s_lshr_b32 s72, s48, 3
    s_add_u32 s72, s72, s49
    s_lshl_b32 s72, s72, 7
    s_add_u32 s73, s72, 12648448
    s_add_u32 s72, s72, 12582912
    s_atomic_swap s68, s[36:37], s72 glc
    s_cmp_ge_u32 s46, 28
    s_cbranch_scc1 NPS
    s_atomic_swap s69, s[36:37], s73 glc
    s_and_b32 s3, s45, 3
    s_add_u32 s3, s3, 2
    s_and_b32 s3, s3, 3
    s_lshl_b32 s4, s50, 2
    s_add_u32 s3, s3, s4
    s_lshl_b32 s3, s3, 5
    s_add_u32 s3, s3, s51
    s_lshl_b32 s3, s3, 7
    s_add_u32 s72, s3, 12713984
    s_and_b32 s3, s45, 3
    s_add_u32 s3, s3, 3
    s_and_b32 s3, s3, 3
    s_lshl_b32 s4, s50, 2
    s_add_u32 s3, s3, s4
    s_lshl_b32 s3, s3, 5
    s_add_u32 s3, s3, s51
    s_lshl_b32 s3, s3, 7
    s_add_u32 s73, s3, 12713984
    s_atomic_swap s70, s[36:37], s72 glc
    s_atomic_swap s71, s[36:37], s73 glc
NPS:
    s_barrier
    s_cmp_lg_u32 s66, 5
    s_cbranch_scc1 RS5
    v_add_u32 v41, 92160, v41
    ds_read_b128 v[44:47], v41
    v_xor_b32 v41, 32, v41
    ds_read_b128 v[48:51], v41
    s_waitcnt lgkmcnt(0)
RS5:
    s_cmp_ge_u32 s46, 28
    s_cbranch_scc1 Y_PREF
    s_add_u32 m0, s58, 0
    s_nop 0
    buffer_load_dwordx4 v10, s[16:19], s62 offen   lds
    s_add_u32 s62, s62, 28672
    s_add_u32 m0, s58, 4096
    s_nop 0
    buffer_load_dwordx4 v10, s[16:19], s62 offen   lds
    s_add_u32 s62, s62, 28672
    s_waitcnt vmcnt(2) lgkmcnt(0)
    s_barrier
    s_add_u32 m0, s58, 8192
    s_nop 0
    buffer_load_dwordx4 v10, s[16:19], s62 offen   lds
    s_add_u32 s62, s62, 28672
    s_add_u32 m0, s58, 12288
    s_nop 0
    buffer_load_dwordx4 v10, s[16:19], s62 offen   lds
    s_add_u32 s62, s62, 28672
    s_add_u32 m0, s58, 16384
    s_nop 0
    buffer_load_dwordx4 v10, s[16:19], s62 offen   lds
    s_add_u32 s62, s62, 28672
    s_add_u32 m0, s58, 20480
    s_nop 0
    buffer_load_dwordx4 v10, s[16:19], s62 offen   lds
    s_add_u32 s62, s62, 28672
    s_add_u32 m0, s58, 24576
    s_nop 0
    buffer_load_dwordx4 v10, s[16:19], s62 offen   lds
    s_add_u32 s62, s62, 28672
    s_add_u32 m0, s58, 28672
    s_nop 0
    buffer_load_dwordx4 v10, s[16:19], s62 offen   lds
    s_add_u32 s62, s62, 28672
    s_cmp_lg_u32 s66, 6
    s_cbranch_scc1 RS6
    v_add_u32 v41, 126976, v41
    ds_read_b128 v[44:47], v41
    v_xor_b32 v41, 32, v41
    ds_read_b128 v[48:51], v41
    s_waitcnt lgkmcnt(0)
RS6:
    s_barrier
    s_add_u32 m0, s58, 32768
    s_nop 0
    buffer_load_dwordx4 v10, s[16:19], s62 offen   lds
    s_add_u32 s62, s62, 28672
    s_add_u32 m0, s58, 36864
    s_nop 0
    buffer_load_dwordx4 v10, s[16:19], s62 offen   lds
    s_add_u32 s62, s62, 28672
    s_add_u32 m0, s58, 40960
    s_nop 0
    buffer_load_dwordx4 v10, s[16:19], s62 offen   lds
    s_add_u32 s62, s62, 28672
    s_add_u32 m0, s58, 45056
    s_nop 0
    buffer_load_dwordx4 v10, s[16:19], s62 offen   lds
    s_add_u32 s62, s62, 28672
    s_add_u32 m0, s58, 49152
    s_nop 0
    buffer_load_dwordx4 v10, s[16:19], s62 offen   lds
    s_add_u32 s62, s62, 28672
    s_add_u32 m0, s58, 53248
    s_nop 0
    buffer_load_dwordx4 v10, s[16:19], s62 offen   lds
    s_add_u32 s62, s62, 28672
    s_add_u32 m0, s59, 57344
    s_nop 0
    buffer_load_dwordx4 v28, s[20:23], s63 offen   lds
    s_add_u32 m0, s59, 58368
    s_nop 0
    buffer_load_dwordx4 v28, s[24:27], s63 offen   lds
    s_add_u32 s63, s63, 114688
    s_add_u32 m0, s59, 65536
    s_nop 0
    buffer_load_dwordx4 v28, s[20:23], s63 offen   lds
    s_add_u32 m0, s59, 66560
    s_nop 0
    buffer_load_dwordx4 v28, s[24:27], s63 offen   lds
    s_add_u32 s63, s63, 114688
    s_add_u32 m0, s59, 73728
    s_nop 0
    buffer_load_dwordx4 v28, s[20:23], s63 offen   lds
    s_add_u32 m0, s59, 74752
    s_nop 0
    buffer_load_dwordx4 v28, s[24:27], s63 offen   lds
    s_add_u32 s63, s63, 114688
    s_add_u32 m0, s59, 81920
    s_nop 0
    buffer_load_dwordx4 v28, s[20:23], s63 offen   lds
    s_add_u32 m0, s59, 82944
    s_nop 0
    buffer_load_dwordx4 v28, s[24:27], s63 offen   lds
    s_add_u32 s63, s63, 114688
    s_add_u32 m0, s59, 90112
    s_nop 0
    buffer_load_dwordx4 v28, s[20:23], s63 offen   lds
    s_add_u32 m0, s59, 91136
    s_nop 0
    buffer_load_dwordx4 v28, s[24:27], s63 offen   lds
    s_add_u32 s63, s63, 114688
    s_add_u32 m0, s59, 98304
    s_nop 0
    buffer_load_dwordx4 v28, s[20:23], s63 offen   lds
    s_add_u32 m0, s59, 99328
    s_nop 0
    buffer_load_dwordx4 v28, s[24:27], s63 offen   lds
    s_add_u32 s63, s63, 114688
    s_add_u32 m0, s59, 106496
    s_nop 0
    buffer_load_dwordx4 v28, s[20:23], s63 offen   lds
    s_add_u32 m0, s59, 107520
    s_nop 0
    buffer_load_dwordx4 v28, s[24:27], s63 offen   lds
    s_add_u32 s63, s63, 114688
    s_waitcnt vmcnt(14)
    s_barrier
    s_add_u32 m0, s59, 114688
    s_nop 0
    buffer_load_dwordx4 v28, s[20:23], s63 offen   lds
    ds_read_b64_tr_b16 v[52:53], v39 offset:0
    ds_read_b64_tr_b16 v[54:55], v39 offset:2048
    ds_read_b64_tr_b16 v[56:57], v39 offset:1024
    ds_read_b64_tr_b16 v[58:59], v39 offset:3072
    ds_read_b64_tr_b16 v[60:61], v39 offset:3584
    ds_read_b64_tr_b16 v[62:63], v39 offset:5632
    ds_read_b64_tr_b16 v[64:65], v39 offset:4608
    s_add_u32 m0, s59, 115712
    s_nop 0
    buffer_load_dwordx4 v28, s[24:27], s63 offen   lds
    ds_read_b64_tr_b16 v[66:67], v39 offset:6656
    ds_read_b64_tr_b16 v[68:69], v39 offset:7168
    ds_read_b64_tr_b16 v[70:71], v39 offset:9216
    ds_read_b64_tr_b16 v[72:73], v39 offset:8192
    ds_read_b64_tr_b16 v[74:75], v39 offset:10240
    ds_read_b64_tr_b16 v[76:77], v39 offset:10752
    ds_read_b64_tr_b16 v[78:79], v39 offset:12800
    s_add_u32 s63, s63, 114688
    s_add_u32 m0, s59, 122880
    s_nop 0
    buffer_load_dwordx4 v28, s[20:23], s63 offen   lds
    ds_read_b64_tr_b16 v[80:81], v39 offset:11776
    ds_read_b64_tr_b16 v[82:83], v39 offset:13824
    ds_read_b64_tr_b16 v[84:85], v39 offset:14336
    ds_read_b64_tr_b16 v[86:87], v39 offset:16384
    ds_read_b64_tr_b16 v[88:89], v39 offset:15360
    ds_read_b64_tr_b16 v[90:91], v39 offset:17408
    ds_read_b64_tr_b16 v[92:93], v39 offset:17920
    s_add_u32 m0, s59, 123904
    s_nop 0
    buffer_load_dwordx4 v28, s[24:27], s63 offen   lds
    ds_read_b64_tr_b16 v[94:95], v39 offset:19968
    ds_read_b64_tr_b16 v[96:97], v39 offset:18944
    ds_read_b64_tr_b16 v[98:99], v39 offset:20992
    ds_read_b64_tr_b16 v[100:101], v39 offset:21504
    ds_read_b64_tr_b16 v[102:103], v39 offset:23552
    ds_read_b64_tr_b16 v[104:105], v39 offset:22528
    ds_read_b64_tr_b16 v[106:107], v39 offset:24576
    s_add_u32 s63, s63, 114688
    s_add_u32 m0, s59, 131072
    s_nop 0
    buffer_load_dwordx4 v28, s[20:23], s63 offen   lds
    ds_read_b64_tr_b16 v[108:109], v39 offset:25088
    ds_read_b64_tr_b16 v[110:111], v39 offset:27136
    ds_read_b64_tr_b16 v[112:113], v39 offset:26112
    ds_read_b64_tr_b16 v[114:115], v39 offset:28160
    ds_read_b64_tr_b16 v[116:117], v39 offset:28672
    ds_read_b64_tr_b16 v[118:119], v39 offset:30720
    ds_read_b64_tr_b16 v[120:121], v39 offset:29696
    s_add_u32 m0, s59, 132096
    s_nop 0
    buffer_load_dwordx4 v28, s[24:27], s63 offen   lds
    ds_read_b64_tr_b16 v[122:123], v39 offset:31744
    ds_read_b64_tr_b16 v[124:125], v39 offset:32256
    ds_read_b64_tr_b16 v[126:127], v39 offset:34304
    ds_read_b64_tr_b16 v[128:129], v39 offset:33280
    ds_read_b64_tr_b16 v[130:131], v39 offset:35328
    ds_read_b64_tr_b16 v[132:133], v39 offset:35840
    ds_read_b64_tr_b16 v[134:135], v39 offset:37888
    s_add_u32 s63, s63, 114688
    s_add_u32 m0, s59, 139264
    s_nop 0
    buffer_load_dwordx4 v28, s[20:23], s63 offen   lds
    ds_read_b64_tr_b16 v[136:137], v39 offset:36864
    ds_read_b64_tr_b16 v[138:139], v39 offset:38912
    ds_read_b64_tr_b16 v[140:141], v39 offset:39424
    ds_read_b64_tr_b16 v[142:143], v39 offset:41472
    ds_read_b64_tr_b16 v[144:145], v39 offset:40448
    ds_read_b64_tr_b16 v[146:147], v39 offset:42496
    ds_read_b64_tr_b16 v[148:149], v39 offset:43008
    s_add_u32 m0, s59, 140288
    s_nop 0
    buffer_load_dwordx4 v28, s[24:27], s63 offen   lds
    ds_read_b64_tr_b16 v[150:151], v39 offset:45056
    ds_read_b64_tr_b16 v[152:153], v39 offset:44032
    ds_read_b64_tr_b16 v[154:155], v39 offset:46080
    ds_read_b64_tr_b16 v[156:157], v39 offset:46592
    ds_read_b64_tr_b16 v[158:159], v39 offset:48640
    ds_read_b64_tr_b16 v[160:161], v39 offset:47616
    ds_read_b64_tr_b16 v[162:163], v39 offset:49664
    s_add_u32 s63, s63, 114688
    s_add_u32 m0, s59, 147456
    s_nop 0
    buffer_load_dwordx4 v28, s[20:23], s63 offen   lds
    ds_read_b64_tr_b16 v[164:165], v39 offset:50176
    ds_read_b64_tr_b16 v[166:167], v39 offset:52224
    ds_read_b64_tr_b16 v[168:169], v39 offset:51200
    ds_read_b64_tr_b16 v[170:171], v39 offset:53248
    ds_read_b64_tr_b16 v[172:173], v39 offset:53760
    ds_read_b64_tr_b16 v[174:175], v39 offset:55808
    ds_read_b64_tr_b16 v[176:177], v39 offset:54784
    s_add_u32 m0, s59, 148480
    s_nop 0
    buffer_load_dwordx4 v28, s[24:27], s63 offen   lds
    ds_read_b64_tr_b16 v[178:179], v39 offset:56832
    s_add_u32 s63, s63, 114688
    s_branch PG_11
.p2align 12
STUB_y2:
    s_setpc_b64 s[6:7]
    s_nop 0
PG_11:
    s_waitcnt vmcnt(8) lgkmcnt(0)
    s_barrier
    s_add_u32 m0, s59, 0
    s_nop 0
    buffer_load_dwordx4 v28, s[20:23], s63 offen   lds
    s_add_u32 m0, s59, 1024
    s_nop 0
    buffer_load_dwordx4 v28, s[24:27], s63 offen   lds
    s_add_u32 s63, s63, 114688
    s_add_u32 m0, s59, 8192
    s_nop 0
    buffer_load_dwordx4 v28, s[20:23], s63 offen   lds
    s_add_u32 m0, s59, 9216
    s_nop 0
    buffer_load_dwordx4 v28, s[24:27], s63 offen   lds
    s_add_u32 s63, s63, 114688
    v_lshlrev_b32 v12, 16, v44
    v_and_b32 v13, 0xffff0000, v44
    v_lshlrev_b32 v14, 16, v45
    v_and_b32 v15, 0xffff0000, v45
    v_lshlrev_b32 v16, 16, v46
    v_and_b32 v17, 0xffff0000, v46
    v_lshlrev_b32 v18, 16, v47
    v_and_b32 v19, 0xffff0000, v47
    v_lshlrev_b32 v20, 16, v48
    v_and_b32 v21, 0xffff0000, v48
    v_lshlrev_b32 v22, 16, v49
    v_and_b32 v23, 0xffff0000, v49
    v_lshlrev_b32 v24, 16, v50
    v_and_b32 v25, 0xffff0000, v50
    v_lshlrev_b32 v26, 16, v51
    v_and_b32 v27, 0xffff0000, v51
    s_lshl_b32 s57, s54, 9
    s_add_u32 s57, s57, 12582912
    s_mov_b64 s[66:67], 0xff
    s_lshl_b32 s55, s54, 15
    s_lshl_b32 s56, s44, 14
    s_add_u32 s55, s55, s56
    s_add_u32 s55, s55, 0
    s_setprio 2
    s_cmp_lg_u32 s44, 1
    s_cbranch_scc1 YF1
    s_mov_b64 exec, s[66:67]
    s_mov_b32 s5, 0
    s_mov_b64 s[76:77], 0
DP_12:
    s_add_u32 s5, s5, 1
    s_and_b32 s6, s5, 3
    s_cselect_b64 s[68:69], 0, -1
    s_cselect_b32 s6, 32768, 0
    s_add_u32 s6, s6, s57
    buffer_load_dwordx4 v[180:183], v42, s[36:39], s6 offen sc1
    s_cmp_gt_u32 s5, 40000
    s_cbranch_scc1 DPD_13
    s_waitcnt vmcnt(0)
    v_xor_b32 v181, v181, v180
    v_xor_b32 v182, v182, v180
    v_xor_b32 v183, v183, v180
    v_or3_b32 v181, v181, v182, v183
    v_cmp_eq_u32 vcc, 0, v181
    s_nop 0
    s_or_b64 s[68:69], s[68:69], vcc
    v_cmp_eq_u32 vcc, s47, v180
    s_nop 0
    s_and_b64 s[68:69], s[68:69], vcc
    s_or_b64 s[76:77], s[76:77], s[68:69]
    s_andn2_b64 s[6:7], s[66:67], s[76:77]
    s_cbranch_scc1 DP_12
DPD_13:
    s_mov_b64 exec, -1
YF1:
    s_waitcnt vmcnt(0)
    s_barrier
    s_add_u32 m0, s56, 57344
    s_nop 0
    buffer_load_dwordx4 v2, s[36:39], s55 offen  sc1 lds
    buffer_load_dwordx4 v2, s[36:39], s55 offen offset:1024 sc1 lds
    buffer_load_dwordx4 v2, s[36:39], s55 offen offset:2048 sc1 lds
    buffer_load_dwordx4 v2, s[36:39], s55 offen offset:3072 sc1 lds
    s_add_u32 m0, s56, 61440
    s_add_u32 s55, s55, 4096
    buffer_load_dwordx4 v2, s[36:39], s55 offen  sc1 lds
    buffer_load_dwordx4 v2, s[36:39], s55 offen offset:1024 sc1 lds
    buffer_load_dwordx4 v2, s[36:39], s55 offen offset:2048 sc1 lds
    buffer_load_dwordx4 v2, s[36:39], s55 offen offset:3072 sc1 lds
    s_add_u32 m0, s56, 65536
    s_add_u32 s55, s55, 4096
    buffer_load_dwordx4 v2, s[36:39], s55 offen  sc1 lds
    buffer_load_dwordx4 v2, s[36:39], s55 offen offset:1024 sc1 lds
    buffer_load_dwordx4 v2, s[36:39], s55 offen offset:2048 sc1 lds
    buffer_load_dwordx4 v2, s[36:39], s55 offen offset:3072 sc1 lds
    s_add_u32 m0, s56, 69632
    s_add_u32 s55, s55, 4096
    buffer_load_dwordx4 v2, s[36:39], s55 offen  sc1 lds
    buffer_load_dwordx4 v2, s[36:39], s55 offen offset:1024 sc1 lds
    buffer_load_dwordx4 v2, s[36:39], s55 offen offset:2048 sc1 lds
    buffer_load_dwordx4 v2, s[36:39], s55 offen offset:3072 sc1 lds
    s_waitcnt vmcnt(12)
    s_barrier
    ds_read_b128 v[180:183], v40 offset:0
    ds_read_b128 v[184:187], v40 offset:512
    ds_read_b128 v[188:191], v40 offset:1024
    ds_read_b128 v[192:195], v40 offset:1536
    s_waitcnt lgkmcnt(3)
    v_mfma_f32_32x32x16_bf16 v[12:27], v[52:55], v[180:183], v[12:27]
    ds_read_b128 v[196:199], v40 offset:2048
    s_waitcnt lgkmcnt(3)
    v_mfma_f32_32x32x16_bf16 v[12:27], v[56:59], v[184:187], v[12:27]
    ds_read_b128 v[200:203], v40 offset:2560
    s_waitcnt lgkmcnt(3)
    v_mfma_f32_32x32x16_bf16 v[12:27], v[60:63], v[188:191], v[12:27]
    ds_read_b128 v[180:183], v40 offset:3072
    s_waitcnt lgkmcnt(3)
    v_mfma_f32_32x32x16_bf16 v[12:27], v[64:67], v[192:195], v[12:27]
    ds_read_b128 v[184:187], v40 offset:3584
    s_waitcnt vmcnt(8)
    s_barrier
    s_waitcnt lgkmcnt(3)
    v_mfma_f32_32x32x16_bf16 v[12:27], v[68:71], v[196:199], v[12:27]
    ds_read_b128 v[188:191], v40 offset:4096
    s_waitcnt lgkmcnt(3)
    v_mfma_f32_32x32x16_bf16 v[12:27], v[72:75], v[200:203], v[12:27]
    ds_read_b128 v[192:195], v40 offset:4608
    s_waitcnt lgkmcnt(3)
    v_mfma_f32_32x32x16_bf16 v[12:27], v[76:79], v[180:183], v[12:27]
    ds_read_b128 v[196:199], v40 offset:5120
    s_waitcnt lgkmcnt(3)
    v_mfma_f32_32x32x16_bf16 v[12:27], v[80:83], v[184:187], v[12:27]
    ds_read_b128 v[200:203], v40 offset:5632
    s_waitcnt lgkmcnt(3)
    v_mfma_f32_32x32x16_bf16 v[12:27], v[84:87], v[188:191], v[12:27]
    ds_read_b128 v[180:183], v40 offset:6144
    s_waitcnt lgkmcnt(3)
    v_mfma_f32_32x32x16_bf16 v[12:27], v[88:91], v[192:195], v[12:27]
    ds_read_b128 v[184:187], v40 offset:6656
    s_waitcnt lgkmcnt(3)
    v_mfma_f32_32x32x16_bf16 v[12:27], v[92:95], v[196:199], v[12:27]
    ds_read_b128 v[188:191], v40 offset:7168
    s_waitcnt lgkmcnt(3)
    v_mfma_f32_32x32x16_bf16 v[12:27], v[96:99], v[200:203], v[12:27]
    ds_read_b128 v[192:195], v40 offset:7680
    s_waitcnt vmcnt(4)
    s_barrier
    s_waitcnt lgkmcnt(3)
    v_mfma_f32_32x32x16_bf16 v[12:27], v[100:103], v[180:183], v[12:27]
    ds_read_b128 v[196:199], v40 offset:8192
    s_waitcnt lgkmcnt(3)
    v_mfma_f32_32x32x16_bf16 v[12:27], v[104:107], v[184:187], v[12:27]
    ds_read_b128 v[200:203], v40 offset:8704
    s_waitcnt lgkmcnt(3)
    v_mfma_f32_32x32x16_bf16 v[12:27], v[108:111], v[188:191], v[12:27]
    ds_read_b128 v[180:183], v40 offset:9216
    s_waitcnt lgkmcnt(3)
    v_mfma_f32_32x32x16_bf16 v[12:27], v[112:115], v[192:195], v[12:27]
    ds_read_b128 v[184:187], v40 offset:9728
    s_waitcnt lgkmcnt(3)
    v_mfma_f32_32x32x16_bf16 v[12:27], v[116:119], v[196:199], v[12:27]
    ds_read_b128 v[188:191], v40 offset:10240
    s_waitcnt lgkmcnt(3)
    v_mfma_f32_32x32x16_bf16 v[12:27], v[120:123], v[200:203], v[12:27]
    ds_read_b128 v[192:195], v40 offset:10752
    s_waitcnt lgkmcnt(3)
    v_mfma_f32_32x32x16_bf16 v[12:27], v[124:127], v[180:183], v[12:27]
    ds_read_b128 v[196:199], v40 offset:11264
    s_waitcnt lgkmcnt(3)
    v_mfma_f32_32x32x16_bf16 v[12:27], v[128:131], v[184:187], v[12:27]
    ds_read_b128 v[200:203], v40 offset:11776
    s_waitcnt vmcnt(0)
    s_barrier
    s_waitcnt lgkmcnt(3)
    v_mfma_f32_32x32x16_bf16 v[12:27], v[132:135], v[188:191], v[12:27]
    ds_read_b128 v[180:183], v40 offset:12288
    s_waitcnt lgkmcnt(3)
    v_mfma_f32_32x32x16_bf16 v[12:27], v[136:139], v[192:195], v[12:27]
    ds_read_b128 v[184:187], v40 offset:12800
    s_waitcnt lgkmcnt(3)
    v_mfma_f32_32x32x16_bf16 v[12:27], v[140:143], v[196:199], v[12:27]
    ds_read_b128 v[188:191], v40 offset:13312
    s_waitcnt lgkmcnt(3)
    v_mfma_f32_32x32x16_bf16 v[12:27], v[144:147], v[200:203], v[12:27]
    ds_read_b128 v[192:195], v40 offset:13824
    s_waitcnt lgkmcnt(3)
    v_mfma_f32_32x32x16_bf16 v[12:27], v[148:151], v[180:183], v[12:27]
    ds_read_b128 v[196:199], v40 offset:14336
    s_waitcnt lgkmcnt(3)
    v_mfma_f32_32x32x16_bf16 v[12:27], v[152:155], v[184:187], v[12:27]
    ds_read_b128 v[200:203], v40 offset:14848
    s_waitcnt lgkmcnt(3)
    v_mfma_f32_32x32x16_bf16 v[12:27], v[156:159], v[188:191], v[12:27]
    ds_read_b128 v[180:183], v40 offset:15360
    s_waitcnt lgkmcnt(3)
    v_mfma_f32_32x32x16_bf16 v[12:27], v[160:163], v[192:195], v[12:27]
    ds_read_b128 v[184:187], v40 offset:15872
    s_waitcnt lgkmcnt(3)
    v_mfma_f32_32x32x16_bf16 v[12:27], v[164:167], v[196:199], v[12:27]
    s_waitcnt lgkmcnt(2)
    v_mfma_f32_32x32x16_bf16 v[12:27], v[168:171], v[200:203], v[12:27]
    s_waitcnt lgkmcnt(1)
    v_mfma_f32_32x32x16_bf16 v[12:27], v[172:175], v[180:183], v[12:27]
    s_waitcnt lgkmcnt(0)
    v_mfma_f32_32x32x16_bf16 v[12:27], v[176:179], v[184:187], v[12:27]
    s_lshl_b32 s55, s60, 15
    s_lshl_b32 s3, s61, 11
    s_add_u32 s56, s55, s3
    s_add_u32 s56, s56, 2097152
    s_lshl_b32 s3, s61, 7
    s_add_u32 s55, s55, s3
    s_add_u32 s55, s55, 2125824
    s_nop 4
    v_cvt_pk_bf16_f32 v44, v12, v13
    v_cvt_pk_bf16_f32 v45, v14, v15
    v_cvt_pk_bf16_f32 v46, v16, v17
    v_cvt_pk_bf16_f32 v47, v18, v19
    v_cvt_pk_bf16_f32 v48, v20, v21
    v_cvt_pk_bf16_f32 v49, v22, v23
    v_cvt_pk_bf16_f32 v50, v24, v25
    v_cvt_pk_bf16_f32 v51, v26, v27
    buffer_store_dwordx4 v[44:47], v2, s[36:39], s56 offen sc1
    buffer_store_dwordx4 v[48:51], v2, s[36:39], s56 offen offset:1024 sc1
    v_pk_add_f32 v[180:181], v[12:13], v[14:15]
    v_pk_mul_f32 v[182:183], v[12:13], v[12:13]
    v_pk_fma_f32 v[182:183], v[14:15], v[14:15], v[182:183]
    v_pk_add_f32 v[180:181], v[180:181], v[16:17]
    v_pk_fma_f32 v[182:183], v[16:17], v[16:17], v[182:183]
    v_pk_add_f32 v[180:181], v[180:181], v[18:19]
    v_pk_fma_f32 v[182:183], v[18:19], v[18:19], v[182:183]
    v_pk_add_f32 v[180:181], v[180:181], v[20:21]
    v_pk_fma_f32 v[182:183], v[20:21], v[20:21], v[182:183]
    v_pk_add_f32 v[180:181], v[180:181], v[22:23]
    v_pk_fma_f32 v[182:183], v[22:23], v[22:23], v[182:183]
    v_pk_add_f32 v[180:181], v[180:181], v[24:25]
    v_pk_fma_f32 v[182:183], v[24:25], v[24:25], v[182:183]
    v_pk_add_f32 v[180:181], v[180:181], v[26:27]
    v_pk_fma_f32 v[182:183], v[26:27], v[26:27], v[182:183]
    v_add_f32 v184, v180, v181
    v_add_f32 v185, v182, v183
    s_nop 1
    v_permlane32_swap_b32 v184, v185
    v_add_f32 v184, v184, v185
    buffer_store_dword v184, v43, s[36:39], s55 offen sc1
    s_and_b32 s3, s44, 1
    s_add_u32 s3, s3, s54
    s_mul_i32 s4, s3, 114688
    s_lshr_b32 s3, s44, 1
    s_mul_i32 s3, s3, 14336
    s_add_u32 s4, s4, s3
    s_add_u32 s4, s4, 4194304
    s_lshl_b32 s59, s44, 12
    s_lshl_b32 s74, s54, 11
    s_add_u32 s74, s74, 12713984
    s_sub_u32 s3, s52, 0
    s_and_b32 s3, s3, 3
    s_mul_i32 s3, s3, 28672
    s_add_u32 s55, s3, s4
    s_sub_u32 s3, s52, 1
    s_and_b32 s3, s3, 3
    s_mul_i32 s3, s3, 28672
    s_add_u32 s56, s3, s4
    s_sub_u32 s3, s52, 2
    s_and_b32 s3, s3, 3
    s_mul_i32 s3, s3, 28672
    s_add_u32 s57, s3, s4
    s_sub_u32 s3, s52, 3
    s_and_b32 s3, s3, 3
    s_mul_i32 s3, s3, 28672
    s_add_u32 s58, s3, s4
    s_lshr_b32 s3, s44, 1
    s_mul_i32 s4, s3, 200704
    s_and_b32 s3, s44, 1
    s_mul_i32 s3, s3, 28672
    s_add_u32 s4, s4, s3
    s_lshl_b32 s3, s53, 7
    s_add_u32 s4, s4, s3
    s_sub_u32 s3, s52, 0
    s_and_b32 s3, s3, 3
    s_mul_i32 s3, s3, 401408
    s_add_u32 s70, s3, s4
    s_sub_u32 s3, s52, 1
    s_and_b32 s3, s3, 3
    s_mul_i32 s3, s3, 401408
    s_add_u32 s71, s3, s4
    s_sub_u32 s3, s52, 2
    s_and_b32 s3, s3, 3
    s_mul_i32 s3, s3, 401408
    s_add_u32 s72, s3, s4
    s_sub_u32 s3, s52, 3
    s_and_b32 s3, s3, 3
    s_mul_i32 s3, s3, 401408
    s_add_u32 s73, s3, s4
    s_and_b32 s60, s45, 3
    s_lshl_b32 s60, s60, 1
    s_mul_i32 s62, s44, 7168
    s_lshl_b32 s61, s50, 18
    s_add_u32 s61, s61, s62
    s_add_u32 s61, s61, 2097152
    s_and_b32 s63, s44, 1
    s_lshl_b32 s63, s63, 6
    s_lshr_b32 s64, s44, 1
    s_lshl_b32 s64, s64, 13
    v_bfe_u32 v3, v1, 2, 2
    v_lshrrev_b32 v4, 5, v1
    v_lshl_add_u32 v5, v4, 3, v3
    v_lshlrev_b32 v5, 7, v5
    v_and_b32 v3, 2, v3
    v_lshlrev_b32 v3, 5, v3
    v_and_b32 v4, 16, v1
    v_lshlrev_b32 v4, 1, v4
    v_and_b32 v6, 1, v1
    v_lshl_or_b32 v4, v6, 4, v4
    v_and_b32 v6, 2, v1
    v_lshl_or_b32 v4, v6, 2, v4
    v_or_b32 v4, s63, v4
    v_xor_b32 v4, v4, v3
    v_add3_u32 v28, v4, v5, s64
    v_add_u32 v29, 122880, v28
    s_lshr_b32 s3, s44, 1
    s_mul_i32 s3, s3, 12288
    v_add_u32 v30, s3, v2
    v_xor_b32 v33, 4096, v30
    v_add_u32 v31, 65536, v30
    v_add_u32 v34, 65536, v33
    v_add_u32 v32, 131072, v30
    v_add_u32 v35, 131072, v33
    v_and_b32 v3, 31, v1
    v_lshrrev_b32 v4, 5, v1
    v_lshrrev_b32 v5, 3, v1
    v_mul_u32_u24 v36, 896, v5
    v_and_b32 v6, 7, v1
    v_lshl_add_u32 v36, v6, 4, v36
    v_xor_b32 v250, v6, v5
    v_lshlrev_b32 v250, 4, v250
    v_lshl_add_u32 v250, v5, 7, v250
    s_lshl_b32 s3, s44, 11
    s_add_u32 s3, s3, 49152
    v_add_u32 v250, s3, v250
    s_and_b32 s3, s44, 1
    s_lshl_b32 s3, s3, 2
    v_or_b32 v248, s3, v4
    v_xor_b32 v248, v248, v6
    v_lshlrev_b32 v248, 4, v248
    v_lshl_add_u32 v248, v3, 7, v248
    s_lshr_b32 s3, s44, 1
    s_lshl_b32 s3, s3, 12
    s_add_u32 s3, s3, 49152
    v_add_u32 v248, s3, v248
    v_xor_b32 v249, 32, v248
    v_lshlrev_b32 v37, 7, v1
    s_lshl_b32 s3, s44, 7
    s_add_u32 s3, s3, 118784
    v_and_b32 v6, 7, v1
    v_lshlrev_b32 v6, 4, v6
    v_lshl_add_u32 v6, v4, 3, v6
    v_bfe_u32 v5, v1, 4, 1
    v_lshl_add_u32 v6, v5, 2, v6
    v_add_u32 v6, s3, v6
    s_barrier
    ds_read_b64_tr_b16 v[88:89], v28 offset:0
    ds_read_b64_tr_b16 v[90:91], v28 offset:512
    ds_read_b64_tr_b16 v[92:93], v28 offset:2048
    ds_read_b64_tr_b16 v[94:95], v28 offset:2560
    ds_read_b64_tr_b16 v[96:97], v28 offset:4096
    ds_read_b64_tr_b16 v[98:99], v28 offset:4608
    ds_read_b64_tr_b16 v[100:101], v28 offset:6144
    ds_read_b64_tr_b16 v[102:103], v28 offset:6656
    ds_read_b64_tr_b16 v[104:105], v28 offset:16384
    ds_read_b64_tr_b16 v[106:107], v28 offset:16896
    ds_read_b64_tr_b16 v[108:109], v28 offset:18432
    ds_read_b64_tr_b16 v[110:111], v28 offset:18944
    ds_read_b64_tr_b16 v[112:113], v28 offset:20480
    ds_read_b64_tr_b16 v[114:115], v28 offset:20992
    ds_read_b64_tr_b16 v[116:117], v28 offset:22528
    ds_read_b64_tr_b16 v[118:119], v28 offset:23040
    ds_read_b64_tr_b16 v[120:121], v29 offset:0
    ds_read_b64_tr_b16 v[122:123], v29 offset:512
    ds_read_b64_tr_b16 v[124:125], v29 offset:2048
    ds_read_b64_tr_b16 v[126:127], v29 offset:2560
    ds_read_b64_tr_b16 v[128:129], v29 offset:4096
    ds_read_b64_tr_b16 v[130:131], v29 offset:4608
    ds_read_b64_tr_b16 v[132:133], v29 offset:6144
    ds_read_b64_tr_b16 v[134:135], v29 offset:6656
    ds_read_b64_tr_b16 v[136:137], v29 offset:16384
    ds_read_b64_tr_b16 v[138:139], v29 offset:16896
    ds_read_b64_tr_b16 v[140:141], v29 offset:18432
    ds_read_b64_tr_b16 v[142:143], v29 offset:18944
    ds_read_b64_tr_b16 v[144:145], v29 offset:20480
    ds_read_b64_tr_b16 v[146:147], v29 offset:20992
    ds_read_b64_tr_b16 v[148:149], v29 offset:22528
    ds_read_b64_tr_b16 v[150:151], v29 offset:23040
    s_waitcnt lgkmcnt(0)
    s_barrier
    s_lshl_b32 s75, s54, 2
    s_add_u32 s75, s75, s53
    s_lshl_b32 s75, s75, 7
    s_add_u32 s75, s75, 12648448
    s_waitcnt vmcnt(0)
    s_mov_b64 exec, 1
    v_mov_b32 v3, s47
    s_lshl_b32 s6, s44, 2
    v_mov_b32 v4, s6
    s_add_u32 s6, s75, 32768
    buffer_store_dword v3, v4, s[36:39], s6 offen
    s_mov_b64 exec, -1
    s_atomic_add s0, s[36:37], s75
    s_lshl_b32 s65, s50, 12
    s_add_u32 s65, s65, 12648448
    s_lshl_b32 s3, s52, 1
    s_lshl_b32 s3, s3, 2
    s_lshl_b32 s66, 0x7f, s3
    s_mov_b32 s67, 0
    s_cmp_lg_u32 s44, 1
    s_cbranch_scc1 YF2
    s_mov_b64 exec, s[66:67]
    s_mov_b32 s5, 0
    s_mov_b64 s[76:77], 0
DP_14:
    s_add_u32 s5, s5, 1
    s_and_b32 s6, s5, 3
    s_cselect_b64 s[68:69], 0, -1
    s_cselect_b32 s6, 32768, 0
    s_add_u32 s6, s6, s65
    buffer_load_dwordx4 v[84:87], v37, s[36:39], s6 offen sc1
    s_cmp_gt_u32 s5, 40000
    s_cbranch_scc1 DPD_15
    s_waitcnt vmcnt(0)
    v_xor_b32 v85, v85, v84
    v_xor_b32 v86, v86, v84
    v_xor_b32 v87, v87, v84
    v_or3_b32 v85, v85, v86, v87
    v_cmp_eq_u32 vcc, 0, v85
    s_nop 0
    s_or_b64 s[68:69], s[68:69], vcc
    v_cmp_eq_u32 vcc, s47, v84
    s_nop 0
    s_and_b64 s[68:69], s[68:69], vcc
    s_or_b64 s[76:77], s[76:77], s[68:69]
    s_andn2_b64 s[6:7], s[66:67], s[76:77]
    s_cbranch_scc1 DP_14
DPD_15:
    s_mov_b64 exec, -1
YF2:
    s_barrier
    s_setprio 0
    s_add_u32 s60, s60, 1
    s_cmp_ge_u32 s44, 2
    s_cbranch_scc1 SLs0
    s_lshl_b32 s3, s52, 1
    s_add_u32 s3, s3, s44
    s_add_u32 s3, s3, 0
    s_and_b32 s3, s3, 7
    s_lshl_b32 s3, s3, 15
    s_lshl_b32 s4, s50, 18
    s_add_u32 s3, s3, s4
    s_add_u32 s3, s3, 2125824
    v_mov_b32 v60, 0
    v_mov_b32 v61, 0
    v_mov_b32 v62, 0
    v_mov_b32 v63, 0
    buffer_load_dwordx4 v[56:59], v2, s[36:39], s3 offen offset:0 sc1
    s_mov_b32 exec_hi, 0xffff
    buffer_load_dwordx4 v[60:63], v2, s[36:39], s3 offen offset:1024 sc1
    s_mov_b64 exec, -1
SLs0:
    s_lshl_b32 s3, s60, 15
    s_add_u32 s3, s3, s61
    s_add_u32 s60, s60, 1
    s_and_b32 s60, s60, 7
    s_add_u32 m0, s62, 90112
    s_nop 0
    buffer_load_dwordx4 v2, s[36:39], s3 offen  sc1 lds
    buffer_load_dwordx4 v2, s[36:39], s3 offen offset:1024 sc1 lds
    buffer_load_dwordx4 v2, s[36:39], s3 offen offset:2048 sc1 lds
    buffer_load_dwordx4 v2, s[36:39], s3 offen offset:3072 sc1 lds
    s_add_u32 m0, s62, 94208
    s_add_u32 s3, s3, 4096
    buffer_load_dwordx4 v2, s[36:39], s3 offen  sc1 lds
    buffer_load_dwordx4 v2, s[36:39], s3 offen offset:1024 sc1 lds
    buffer_load_dwordx4 v2, s[36:39], s3 offen offset:2048 sc1 lds
    s_xor_b32 s66, s66, 0x7f7f7f7f
    s_barrier
    s_barrier
    s_cmp_lg_u32 s44, 2
    s_cbranch_scc1 YF3
    s_mov_b64 exec, s[66:67]
    s_mov_b32 s5, 0
POLL_16:
    buffer_load_dword v3, v37, s[36:39], s65 offen sc1
    s_waitcnt vmcnt(0)
    v_cmp_eq_u32 s[76:77], s47, v3
    s_add_u32 s5, s5, 1
    s_cmp_gt_u32 s5, 40000
    s_cbranch_scc1 POLLD_17
    s_andn2_b64 s[6:7], s[66:67], s[76:77]
    s_cbranch_scc1 POLL_16
POLLD_17:
    s_mov_b64 exec, -1
YF3:
    s_waitcnt vmcnt(7)
    v_add_f32 v56, v56, v60
    v_add_f32 v58, v58, v62
    v_add_f32 v57, v57, v61
    v_add_f32 v59, v59, v63
    v_permlane32_swap_b32 v56, v58
    s_nop 0
    v_permlane32_swap_b32 v57, v59
    v_add_f32 v56, v56, v58
    v_add_f32 v57, v57, v59
    s_nop 1
    v_permlane16_swap_b32 v56, v57
    v_add_f32 v56, v56, v57
    s_nop 1
    v_add_f32_dpp v56, v56, v56 row_ror:8 row_mask:0xf bank_mask:0xf
    ds_write_b32 v6, v56 offset:0
    s_waitcnt vmcnt(0) lgkmcnt(0)
    s_barrier
    s_lshl_b32 s3, s60, 15
    s_add_u32 s3, s3, s61
    s_add_u32 s60, s60, 1
    s_and_b32 s60, s60, 7
    s_add_u32 m0, s62, 32768
    s_nop 0
    buffer_load_dwordx4 v2, s[36:39], s3 offen  sc1 lds
    buffer_load_dwordx4 v2, s[36:39], s3 offen offset:1024 sc1 lds
    buffer_load_dwordx4 v2, s[36:39], s3 offen offset:2048 sc1 lds
    buffer_load_dwordx4 v2, s[36:39], s3 offen offset:3072 sc1 lds
    s_add_u32 m0, s62, 36864
    s_add_u32 s3, s3, 4096
    buffer_load_dwordx4 v2, s[36:39], s3 offen  sc1 lds
    buffer_load_dwordx4 v2, s[36:39], s3 offen offset:1024 sc1 lds
    buffer_load_dwordx4 v2, s[36:39], s3 offen offset:2048 sc1 lds
    s_lshl_b32 s3, s52, 1
    s_add_u32 s3, s3, s44
    s_add_u32 s3, s3, 2
    s_and_b32 s3, s3, 7
    s_lshl_b32 s3, s3, 15
    s_lshl_b32 s4, s50, 18
    s_add_u32 s3, s3, s4
    s_add_u32 s3, s3, 2125824
    v_mov_b32 v60, 0
    v_mov_b32 v61, 0
    v_mov_b32 v62, 0
    v_mov_b32 v63, 0
    buffer_load_dwordx4 v[56:59], v2, s[36:39], s3 offen offset:0 sc1
    s_mov_b32 exec_hi, 0xffff
    buffer_load_dwordx4 v[60:63], v2, s[36:39], s3 offen offset:1024 sc1
    s_mov_b64 exec, -1
    s_lshl_b32 s3, s60, 15
    s_add_u32 s3, s3, s61
    s_add_u32 s60, s60, 1
    s_and_b32 s60, s60, 7
    s_add_u32 m0, s62, 61440
    s_nop 0
    buffer_load_dwordx4 v2, s[36:39], s3 offen  sc1 lds
    ds_read_b64_tr_b16 v[152:153], v28 offset:0
    ds_read_b64_tr_b16 v[154:155], v28 offset:512
    ds_read_b64_tr_b16 v[156:157], v28 offset:2048
    buffer_load_dwordx4 v2, s[36:39], s3 offen offset:1024 sc1 lds
    ds_read_b64_tr_b16 v[158:159], v28 offset:2560
    ds_read_b64_tr_b16 v[160:161], v28 offset:4096
    ds_read_b64_tr_b16 v[162:163], v28 offset:4608
    buffer_load_dwordx4 v2, s[36:39], s3 offen offset:2048 sc1 lds
    ds_read_b64_tr_b16 v[164:165], v28 offset:6144
    ds_read_b64_tr_b16 v[166:167], v28 offset:6656
    ds_read_b64_tr_b16 v[168:169], v28 offset:16384
    buffer_load_dwordx4 v2, s[36:39], s3 offen offset:3072 sc1 lds
    ds_read_b64_tr_b16 v[170:171], v28 offset:16896
    ds_read_b64_tr_b16 v[172:173], v28 offset:18432
    ds_read_b64_tr_b16 v[174:175], v28 offset:18944
    s_add_u32 m0, s62, 65536
    s_add_u32 s3, s3, 4096
    buffer_load_dwordx4 v2, s[36:39], s3 offen  sc1 lds
    ds_read_b64_tr_b16 v[176:177], v28 offset:20480
    ds_read_b64_tr_b16 v[178:179], v28 offset:20992
    ds_read_b64_tr_b16 v[180:181], v28 offset:22528
    buffer_load_dwordx4 v2, s[36:39], s3 offen offset:1024 sc1 lds
    ds_read_b64_tr_b16 v[182:183], v28 offset:23040
    buffer_load_dwordx4 v2, s[36:39], s3 offen offset:2048 sc1 lds
    s_waitcnt vmcnt(9) lgkmcnt(0)
    s_barrier
    s_add_u32 s3, s72, 57344
    s_add_u32 m0, s59, 0
    s_nop 0
    buffer_load_dwordx4 v10, s[28:31], s3 offen   lds
    s_waitcnt vmcnt(8)
    v_add_f32 v56, v56, v60
    v_add_f32 v58, v58, v62
    s_add_u32 s3, s3, 7168
    s_add_u32 m0, s59, 1024
    s_nop 0
    buffer_load_dwordx4 v10, s[28:31], s3 offen   lds
    v_add_f32 v57, v57, v61
    v_add_f32 v59, v59, v63
    s_add_u32 s3, s3, 7168
    s_add_u32 m0, s59, 2048
    s_nop 0
    buffer_load_dwordx4 v10, s[28:31], s3 offen   lds
    v_permlane32_swap_b32 v56, v58
    v_permlane32_swap_b32 v57, v59
    s_add_u32 s3, s3, 7168
    s_add_u32 m0, s59, 3072
    s_nop 0
    buffer_load_dwordx4 v10, s[28:31], s3 offen   lds
    v_add_f32 v56, v56, v58
    v_add_f32 v57, v57, v59
    s_lshl_b32 s3, s60, 15
    s_add_u32 s3, s3, s61
    s_add_u32 s60, s60, 1
    s_and_b32 s60, s60, 7
    s_add_u32 m0, s62, 90112
    s_nop 0
    buffer_load_dwordx4 v2, s[36:39], s3 offen  sc1 lds
    v_permlane16_swap_b32 v56, v57
    v_add_f32 v56, v56, v57
    buffer_load_dwordx4 v2, s[36:39], s3 offen offset:1024 sc1 lds
    s_nop 0
    v_add_f32_dpp v56, v56, v56 row_ror:8 row_mask:0xf bank_mask:0xf
    ds_write_b32 v6, v56 offset:256
    buffer_load_dwordx4 v2, s[36:39], s3 offen offset:2048 sc1 lds
    buffer_load_dwordx4 v2, s[36:39], s3 offen offset:3072 sc1 lds
    s_add_u32 m0, s62, 94208
    s_add_u32 s3, s3, 4096
    buffer_load_dwordx4 v2, s[36:39], s3 offen  sc1 lds
    buffer_load_dwordx4 v2, s[36:39], s3 offen offset:1024 sc1 lds
    buffer_load_dwordx4 v2, s[36:39], s3 offen offset:2048 sc1 lds
    s_branch PG_18
.p2align 12
STUB_y3:
    s_setpc_b64 s[6:7]
    s_nop 0
PG_18:
    s_waitcnt vmcnt(11) lgkmcnt(0)
    s_barrier
    s_cmp_ge_u32 s44, 2
    s_cbranch_scc1 SLs6
    s_lshl_b32 s3, s52, 1
    s_add_u32 s3, s3, s44
    s_add_u32 s3, s3, 6
    s_and_b32 s3, s3, 7
    s_lshl_b32 s3, s3, 15
    s_lshl_b32 s4, s50, 18
    s_add_u32 s3, s3, s4
    s_add_u32 s3, s3, 2125824
    v_mov_b32 v60, 0
    v_mov_b32 v61, 0
    v_mov_b32 v62, 0
    v_mov_b32 v63, 0
    buffer_load_dwordx4 v[56:59], v2, s[36:39], s3 offen offset:0 sc1
    s_mov_b32 exec_hi, 0xffff
    buffer_load_dwordx4 v[60:63], v2, s[36:39], s3 offen offset:1024 sc1
    s_mov_b64 exec, -1
SLs6:
    s_add_u32 s3, s72, 114688
    s_add_u32 m0, s59, 16384
    s_nop 0
    buffer_load_dwordx4 v10, s[28:31], s3 offen   lds
    ds_read_b64_tr_b16 v[184:185], v29 offset:0
    ds_read_b64_tr_b16 v[186:187], v29 offset:512
    s_add_u32 s3, s3, 7168
    s_add_u32 m0, s59, 17408
    s_nop 0
    buffer_load_dwordx4 v10, s[28:31], s3 offen   lds
    ds_read_b64_tr_b16 v[188:189], v29 offset:2048
    ds_read_b64_tr_b16 v[190:191], v29 offset:2560
    s_add_u32 s3, s3, 7168
    s_add_u32 m0, s59, 18432
    s_nop 0
    buffer_load_dwordx4 v10, s[28:31], s3 offen   lds
    ds_read_b64_tr_b16 v[192:193], v29 offset:4096
    ds_read_b64_tr_b16 v[194:195], v29 offset:4608
    s_add_u32 s3, s3, 7168
    s_add_u32 m0, s59, 19456
    s_nop 0
    buffer_load_dwordx4 v10, s[28:31], s3 offen   lds
    ds_read_b64_tr_b16 v[196:197], v29 offset:6144
    ds_read_b64_tr_b16 v[198:199], v29 offset:6656
    s_lshl_b32 s3, s60, 15
    s_add_u32 s3, s3, s61
    s_add_u32 s60, s60, 1
    s_and_b32 s60, s60, 7
    s_add_u32 m0, s62, 32768
    s_nop 0
    buffer_load_dwordx4 v2, s[36:39], s3 offen  sc1 lds
    ds_read_b64_tr_b16 v[200:201], v29 offset:16384
    ds_read_b64_tr_b16 v[202:203], v29 offset:16896
    buffer_load_dwordx4 v2, s[36:39], s3 offen offset:1024 sc1 lds
    ds_read_b64_tr_b16 v[204:205], v29 offset:18432
    ds_read_b64_tr_b16 v[206:207], v29 offset:18944
    buffer_load_dwordx4 v2, s[36:39], s3 offen offset:2048 sc1 lds
    ds_read_b64_tr_b16 v[208:209], v29 offset:20480
    ds_read_b64_tr_b16 v[210:211], v29 offset:20992
    buffer_load_dwordx4 v2, s[36:39], s3 offen offset:3072 sc1 lds
    ds_read_b64_tr_b16 v[212:213], v29 offset:22528
    ds_read_b64_tr_b16 v[214:215], v29 offset:23040
    s_add_u32 m0, s62, 36864
    s_add_u32 s3, s3, 4096
    buffer_load_dwordx4 v2, s[36:39], s3 offen  sc1 lds
    buffer_load_dwordx4 v2, s[36:39], s3 offen offset:1024 sc1 lds
    buffer_load_dwordx4 v2, s[36:39], s3 offen offset:2048 sc1 lds
    s_waitcnt vmcnt(11) lgkmcnt(0)
    s_barrier
    s_cmp_lg_u32 s44, 3
    s_cbranch_scc1 YF_19
    s_and_b32 s3, s45, 3
    s_add_u32 s3, s3, 0
    s_and_b32 s3, s3, 3
    s_lshl_b32 s4, s50, 2
    s_add_u32 s3, s3, s4
    s_lshl_b32 s3, s3, 5
    s_add_u32 s3, s3, s51
    s_lshl_b32 s3, s3, 7
    s_add_u32 s3, s3, 12713984
    s_mov_b64 exec, 1
    v_mov_b32 v8, s47
    v_mov_b32 v9, 0
    s_atomic_swap s47, s[36:37], s3
    s_mov_b64 exec, -1
YF_19:
    s_add_u32 s3, s72, 172032
    s_sub_u32 s4, s73, 28672
    s_bitcmp1_b32 s44, 0
    s_cselect_b32 s3, s4, s3
    s_add_u32 m0, s59, 122880
    s_nop 0
    buffer_load_dwordx4 v10, s[28:31], s3 offen   lds
    ds_read_b64_tr_b16 v[216:217], v28 offset:0
    s_add_u32 s3, s3, 7168
    s_add_u32 m0, s59, 123904
    s_nop 0
    buffer_load_dwordx4 v10, s[28:31], s3 offen   lds
    ds_read_b64_tr_b16 v[218:219], v28 offset:512
    s_add_u32 s3, s3, 7168
    s_add_u32 m0, s59, 124928
    s_nop 0
    buffer_load_dwordx4 v10, s[28:31], s3 offen   lds
    ds_read_b64_tr_b16 v[220:221], v28 offset:2048
    s_add_u32 s3, s3, 7168
    s_add_u32 m0, s59, 125952
    s_nop 0
    buffer_load_dwordx4 v10, s[28:31], s3 offen   lds
    ds_read_b64_tr_b16 v[222:223], v28 offset:2560
    s_lshl_b32 s3, s60, 15
    s_add_u32 s3, s3, s61
    s_add_u32 s60, s60, 1
    s_and_b32 s60, s60, 7
    s_add_u32 m0, s62, 61440
    s_nop 0
    buffer_load_dwordx4 v2, s[36:39], s3 offen  sc1 lds
    ds_read_b64_tr_b16 v[224:225], v28 offset:4096
    buffer_load_dwordx4 v2, s[36:39], s3 offen offset:1024 sc1 lds
    ds_read_b64_tr_b16 v[226:227], v28 offset:4608
    buffer_load_dwordx4 v2, s[36:39], s3 offen offset:2048 sc1 lds
    ds_read_b64_tr_b16 v[228:229], v28 offset:6144
    buffer_load_dwordx4 v2, s[36:39], s3 offen offset:3072 sc1 lds
    ds_read_b64_tr_b16 v[230:231], v28 offset:6656
    s_add_u32 m0, s62, 65536
    s_add_u32 s3, s3, 4096
    buffer_load_dwordx4 v2, s[36:39], s3 offen  sc1 lds
    buffer_load_dwordx4 v2, s[36:39], s3 offen offset:1024 sc1 lds
    buffer_load_dwordx4 v2, s[36:39], s3 offen offset:2048 sc1 lds
    s_waitcnt vmcnt(11) lgkmcnt(0)
    s_barrier
    s_add_u32 s3, s73, 28672
    s_add_u32 m0, s59, 139264
    s_nop 0
    buffer_load_dwordx4 v10, s[28:31], s3 offen   lds
    ds_read_b64_tr_b16 v[232:233], v28 offset:16384
    ds_read_b64_tr_b16 v[234:235], v28 offset:16896
    s_add_u32 s3, s3, 7168
    s_add_u32 m0, s59, 140288
    s_nop 0
    buffer_load_dwordx4 v10, s[28:31], s3 offen   lds
    ds_read_b64_tr_b16 v[236:237], v28 offset:18432
    ds_read_b64_tr_b16 v[238:239], v28 offset:18944
    s_add_u32 s3, s3, 7168
    s_add_u32 m0, s59, 141312
    s_nop 0
    buffer_load_dwordx4 v10, s[28:31], s3 offen   lds
    ds_read_b64_tr_b16 v[240:241], v28 offset:20480
    ds_read_b64_tr_b16 v[242:243], v28 offset:20992
    s_add_u32 s3, s3, 7168
    s_add_u32 m0, s59, 142336
    s_nop 0
    buffer_load_dwordx4 v10, s[28:31], s3 offen   lds
    ds_read_b64_tr_b16 v[244:245], v28 offset:22528
    ds_read_b64_tr_b16 v[246:247], v28 offset:23040
    s_lshl_b32 s3, s60, 15
    s_add_u32 s3, s3, s61
    s_add_u32 s60, s60, 1
    s_and_b32 s60, s60, 7
    s_add_u32 m0, s62, 90112
    s_nop 0
    buffer_load_dwordx4 v2, s[36:39], s3 offen  sc1 lds
    v_add_f32 v56, v56, v60
    v_add_f32 v58, v58, v62
    buffer_load_dwordx4 v2, s[36:39], s3 offen offset:1024 sc1 lds
    v_add_f32 v57, v57, v61
    v_add_f32 v59, v59, v63
    buffer_load_dwordx4 v2, s[36:39], s3 offen offset:2048 sc1 lds
    v_permlane32_swap_b32 v56, v58
    v_permlane32_swap_b32 v57, v59
    buffer_load_dwordx4 v2, s[36:39], s3 offen offset:3072 sc1 lds
    v_add_f32 v56, v56, v58
    v_add_f32 v57, v57, v59
    s_add_u32 m0, s62, 94208
    s_add_u32 s3, s3, 4096
    buffer_load_dwordx4 v2, s[36:39], s3 offen  sc1 lds
    v_permlane16_swap_b32 v56, v57
    v_add_f32 v56, v56, v57
    buffer_load_dwordx4 v2, s[36:39], s3 offen offset:1024 sc1 lds
    s_nop 0
    v_add_f32_dpp v56, v56, v56 row_ror:8 row_mask:0xf bank_mask:0xf
    ds_write_b32 v6, v56 offset:768
    buffer_load_dwordx4 v2, s[36:39], s3 offen offset:2048 sc1 lds
    s_mov_b64 s[66:67], 0
    s_sub_u32 s6, s52, 0
    s_and_b32 s6, s6, 3
    s_mul_i32 s6, s6, 7
    s_lshl_b32 s6, 0x7f, s6
    s_or_b32 s66, s66, s6
    s_mov_b64 exec, s[66:67]
    buffer_load_dword v3, v37, s[36:39], s74 offen sc1
    s_mov_b64 exec, -1
    s_waitcnt vmcnt(12) lgkmcnt(0)
    s_barrier
    s_cmp_lg_u32 s44, 3
    s_cbranch_scc1 YF_20
    s_and_b32 s3, s45, 3
    s_add_u32 s3, s3, 1
    s_and_b32 s3, s3, 3
    s_lshl_b32 s4, s50, 2
    s_add_u32 s3, s3, s4
    s_lshl_b32 s3, s3, 5
    s_add_u32 s3, s3, s51
    s_lshl_b32 s3, s3, 7
    s_add_u32 s3, s3, 12713984
    s_mov_b64 exec, 1
    v_mov_b32 v8, s47
    v_mov_b32 v9, 0
    s_atomic_swap s47, s[36:37], s3
    s_mov_b64 exec, -1
YF_20:
    s_add_u32 s3, s73, 86016
    s_add_u32 m0, s59, 0
    s_nop 0
    buffer_load_dwordx4 v10, s[28:31], s3 offen   lds
    s_add_u32 s3, s3, 7168
    s_add_u32 m0, s59, 1024
    s_nop 0
    buffer_load_dwordx4 v10, s[28:31], s3 offen   lds
    s_add_u32 s3, s3, 7168
    s_add_u32 m0, s59, 2048
    s_nop 0
    buffer_load_dwordx4 v10, s[28:31], s3 offen   lds
    s_add_u32 s3, s3, 7168
    s_add_u32 m0, s59, 3072
    s_nop 0
    buffer_load_dwordx4 v10, s[28:31], s3 offen   lds
    s_add_u32 s3, s73, 143360
    s_add_u32 m0, s59, 16384
    s_nop 0
    buffer_load_dwordx4 v10, s[28:31], s3 offen   lds
    s_add_u32 s3, s3, 7168
    s_add_u32 m0, s59, 17408
    s_nop 0
    buffer_load_dwordx4 v10, s[28:31], s3 offen   lds
    s_add_u32 s3, s3, 7168
    s_add_u32 m0, s59, 18432
    s_nop 0
    buffer_load_dwordx4 v10, s[28:31], s3 offen   lds
    s_add_u32 s3, s3, 7168
    s_add_u32 m0, s59, 19456
    s_nop 0
    buffer_load_dwordx4 v10, s[28:31], s3 offen   lds
    s_mov_b64 exec, s[66:67]
    s_waitcnt vmcnt(8)
    v_cmp_eq_u32 s[68:69], s47, v3
    s_nop 0
    s_andn2_b64 s[6:7], s[66:67], s[68:69]
    s_cbranch_scc0 POLLD_22
    s_mov_b32 s5, 0
POLL_21:
    buffer_load_dword v3, v37, s[36:39], s74 offen sc1
    s_waitcnt vmcnt(0)
    v_cmp_eq_u32 s[68:69], s47, v3
    s_add_u32 s5, s5, 1
    s_cmp_gt_u32 s5, 40000
    s_cbranch_scc1 POLLD_22
    s_andn2_b64 s[6:7], s[66:67], s[68:69]
    s_cbranch_scc1 POLL_21
POLLD_22:
    s_mov_b64 exec, -1
    v_mov_b32 v5, 4
    s_lshl_b32 s63, s44, 2
    s_add_u32 m0, s59, 32768
    s_add_u32 s3, s55, 0
    buffer_load_dwordx4 v2, s[36:39], s3 offen  sc1 lds
    buffer_load_dwordx4 v2, s[36:39], s3 offen offset:1024 sc1 lds
    buffer_load_dwordx4 v2, s[36:39], s3 offen offset:2048 sc1 lds
    buffer_load_dwordx4 v2, s[36:39], s3 offen offset:3072 sc1 lds
    s_add_u32 m0, s63, 162688
    s_mov_b64 exec, 1
    buffer_load_dword v5, s[40:43], 0 offen sc1 lds
    s_mov_b64 exec, -1
    s_waitcnt lgkmcnt(0)
    s_barrier
    s_add_u32 m0, s59, 49152
    s_add_u32 s3, s55, 4096
    buffer_load_dwordx4 v2, s[36:39], s3 offen  sc1 lds
    buffer_load_dwordx4 v2, s[36:39], s3 offen offset:1024 sc1 lds
    buffer_load_dwordx4 v2, s[36:39], s3 offen offset:2048 sc1 lds
    buffer_load_dwordx4 v2, s[36:39], s3 offen offset:3072 sc1 lds
    s_add_u32 m0, s63, 162704
    s_mov_b64 exec, 1
    buffer_load_dword v5, s[40:43], 0 offen sc1 lds
    s_mov_b64 exec, -1
    s_add_u32 m0, s59, 65536
    s_add_u32 s3, s55, 8192
    buffer_load_dwordx4 v2, s[36:39], s3 offen  sc1 lds
    buffer_load_dwordx4 v2, s[36:39], s3 offen offset:1024 sc1 lds
    buffer_load_dwordx4 v2, s[36:39], s3 offen offset:2048 sc1 lds
    buffer_load_dwordx4 v2, s[36:39], s3 offen offset:3072 sc1 lds
    s_add_u32 m0, s63, 162720
    s_mov_b64 exec, 1
    buffer_load_dword v5, s[40:43], 0 offen sc1 lds
    s_mov_b64 exec, -1
    s_and_b32 s3, s44, 2
    s_lshl_b32 s3, s3, 2
    s_add_u32 s3, s3, 162688
    v_mov_b32 v3, s3
    s_lshl_b32 s3, s44, 2
    s_add_u32 s3, s3, 162192
    v_mov_b32 v4, s3
    s_mov_b32 s64, 320000
    s_mov_b32 s69, 0
    v_and_b32 v5, 1, v1
    v_lshl_add_u32 v3, v5, 2, v3
    s_branch PG_23
.p2align 12
STUB_y4:
    s_setpc_b64 s[6:7]
    s_nop 0
PG_23:
    s_lshr_b32 s3, s44, 1
    s_mul_i32 s60, s3, 37888
    s_lshl_b32 s3, s44, 11
    s_add_u32 s60, s60, s3
    s_add_u32 s60, s60, 114688
    s_lshr_b32 s61, s44, 1
    s_lshl_b32 s61, s61, 8
    s_add_u32 s61, s61, 155648
LDt_24:
    ds_read_b32 v8, v3 offset:0
    s_sub_u32 s64, s64, 1
    s_cbranch_scc1 END_Y
    s_waitcnt lgkmcnt(0)
    v_cmp_eq_u32 s[70:71], 0, v8
    s_nop 0
    s_cmp_lg_u64 s[70:71], 0
    s_cbranch_scc1 LDt_24
LDb_25:
    ds_read_b128 v[56:59], v30 offset:32768
    ds_read_b128 v[60:63], v33 offset:32768
    ds_read_b128 v[64:67], v30 offset:33792
    ds_read_b128 v[68:71], v33 offset:33792
    ds_read_b128 v[72:75], v30 offset:34816
    ds_read_b128 v[76:79], v33 offset:34816
    ds_read_b128 v[80:83], v30 offset:35840
    ds_read_b128 v[84:87], v33 offset:35840
    s_waitcnt vmcnt(15)
    s_barrier
    s_waitcnt lgkmcnt(7)
    v_mfma_f32_32x32x16_bf16 v[12:27], v[88:91], v[56:59], 0
    s_waitcnt lgkmcnt(6)
    v_mfma_f32_32x32x16_bf16 v[40:55], v[88:91], v[60:63], 0
    s_waitcnt lgkmcnt(5)
    v_mfma_f32_32x32x16_bf16 v[12:27], v[92:95], v[64:67], v[12:27]
    s_waitcnt lgkmcnt(4)
    v_mfma_f32_32x32x16_bf16 v[40:55], v[92:95], v[68:71], v[40:55]
    ds_read_b32 v8, v3 offset:16
    s_waitcnt lgkmcnt(4)
    v_mfma_f32_32x32x16_bf16 v[12:27], v[96:99], v[72:75], v[12:27]
    s_waitcnt lgkmcnt(0)
    v_cmp_eq_u32 s[70:71], 0, v8
    v_mfma_f32_32x32x16_bf16 v[40:55], v[96:99], v[76:79], v[40:55]
    s_cmp_eq_u64 s[70:71], 0
    s_cbranch_scc1 LDb_27
LDt_26:
    ds_read_b32 v8, v3 offset:16
    s_sub_u32 s64, s64, 1
    s_cbranch_scc1 END_Y
    s_waitcnt lgkmcnt(0)
    v_cmp_eq_u32 s[70:71], 0, v8
    s_nop 0
    s_cmp_lg_u64 s[70:71], 0
    s_cbranch_scc1 LDt_26
LDb_27:
    ds_read_b128 v[56:59], v30 offset:49152
    ds_read_b128 v[60:63], v33 offset:49152
    ds_read_b128 v[64:67], v30 offset:50176
    ds_read_b128 v[68:71], v33 offset:50176
    v_mfma_f32_32x32x16_bf16 v[12:27], v[100:103], v[80:83], v[12:27]
    ds_read_b128 v[72:75], v30 offset:51200
    ds_read_b128 v[76:79], v33 offset:51200
    ds_read_b128 v[80:83], v30 offset:52224
    v_mfma_f32_32x32x16_bf16 v[40:55], v[100:103], v[84:87], v[40:55]
    ds_read_b128 v[84:87], v33 offset:52224
    s_waitcnt lgkmcnt(7)
    v_mfma_f32_32x32x16_bf16 v[12:27], v[104:107], v[56:59], v[12:27]
    ds_read_b64_tr_b16 v[88:89], v29 offset:0
    ds_read_b64_tr_b16 v[90:91], v29 offset:512
    ds_read_b64_tr_b16 v[92:93], v29 offset:2048
    ds_read_b64_tr_b16 v[94:95], v29 offset:2560
    s_waitcnt lgkmcnt(10)
    v_mfma_f32_32x32x16_bf16 v[40:55], v[104:107], v[60:63], v[40:55]
    ds_read_b64_tr_b16 v[96:97], v29 offset:4096
    ds_read_b64_tr_b16 v[98:99], v29 offset:4608
    ds_read_b64_tr_b16 v[100:101], v29 offset:6144
    ds_read_b64_tr_b16 v[102:103], v29 offset:6656
    s_waitcnt lgkmcnt(13)
    v_mfma_f32_32x32x16_bf16 v[12:27], v[108:111], v[64:67], v[12:27]
    s_waitcnt lgkmcnt(12)
    v_mfma_f32_32x32x16_bf16 v[40:55], v[108:111], v[68:71], v[40:55]
    ds_read_b32 v8, v3 offset:32
    s_waitcnt lgkmcnt(12)
    v_mfma_f32_32x32x16_bf16 v[12:27], v[112:115], v[72:75], v[12:27]
    s_waitcnt lgkmcnt(0)
    v_cmp_eq_u32 s[70:71], 0, v8
    v_mfma_f32_32x32x16_bf16 v[40:55], v[112:115], v[76:79], v[40:55]
    s_cmp_eq_u64 s[70:71], 0
    s_cbranch_scc1 LDb_29
LDt_28:
    ds_read_b32 v8, v3 offset:32
    s_sub_u32 s64, s64, 1
    s_cbranch_scc1 END_Y
    s_waitcnt lgkmcnt(0)
    v_cmp_eq_u32 s[70:71], 0, v8
    s_nop 0
    s_cmp_lg_u64 s[70:71], 0
    s_cbranch_scc1 LDt_28
LDb_29:
    ds_read_b128 v[56:59], v31 offset:0
    ds_read_b128 v[60:63], v34 offset:0
    ds_read_b128 v[64:67], v31 offset:1024
    ds_read_b128 v[68:71], v34 offset:1024
    v_mfma_f32_32x32x16_bf16 v[12:27], v[116:119], v[80:83], v[12:27]
    ds_read_b128 v[72:75], v31 offset:2048
    ds_read_b128 v[76:79], v34 offset:2048
    ds_read_b128 v[80:83], v31 offset:3072
    v_mfma_f32_32x32x16_bf16 v[40:55], v[116:119], v[84:87], v[40:55]
    ds_read_b128 v[84:87], v34 offset:3072
    s_setprio 1
    s_waitcnt lgkmcnt(7)
    v_mfma_f32_32x32x16_bf16 v[12:27], v[120:123], v[56:59], v[12:27]
    ds_read_b64_tr_b16 v[104:105], v29 offset:16384
    ds_read_b64_tr_b16 v[106:107], v29 offset:16896
    ds_read_b64_tr_b16 v[108:109], v29 offset:18432
    ds_read_b64_tr_b16 v[110:111], v29 offset:18944
    s_waitcnt lgkmcnt(10)
    v_mfma_f32_32x32x16_bf16 v[40:55], v[120:123], v[60:63], v[40:55]
    ds_read_b64_tr_b16 v[112:113], v29 offset:20480
    ds_read_b64_tr_b16 v[114:115], v29 offset:20992
    ds_read_b64_tr_b16 v[116:117], v29 offset:22528
    ds_read_b64_tr_b16 v[118:119], v29 offset:23040
    s_waitcnt lgkmcnt(13)
    v_mfma_f32_32x32x16_bf16 v[12:27], v[124:127], v[64:67], v[12:27]
    s_waitcnt lgkmcnt(12)
    v_mfma_f32_32x32x16_bf16 v[40:55], v[124:127], v[68:71], v[40:55]
    ds_read_b32 v8, v3 offset:48
    s_waitcnt lgkmcnt(12)
    v_mfma_f32_32x32x16_bf16 v[12:27], v[128:131], v[72:75], v[12:27]
    s_waitcnt lgkmcnt(0)
    v_cmp_eq_u32 s[70:71], 0, v8
    v_mov_b32 v6, 3
    ds_write_b32 v4, v6
    v_mfma_f32_32x32x16_bf16 v[40:55], v[128:131], v[76:79], v[40:55]
    s_cmp_eq_u64 s[70:71], 0
    s_cbranch_scc1 LDb_31
LDt_30:
    ds_read_b32 v8, v3 offset:48
    s_sub_u32 s64, s64, 1
    s_cbranch_scc1 END_Y
    s_waitcnt lgkmcnt(0)
    v_cmp_eq_u32 s[70:71], 0, v8
    s_nop 0
    s_cmp_lg_u64 s[70:71], 0
    s_cbranch_scc1 LDt_30
LDb_31:
    ds_read_b128 v[56:59], v31 offset:16384
    ds_read_b128 v[60:63], v34 offset:16384
    ds_read_b128 v[64:67], v31 offset:17408
    ds_read_b128 v[68:71], v34 offset:17408
    v_mfma_f32_32x32x16_bf16 v[12:27], v[132:135], v[80:83], v[12:27]
    ds_read_b128 v[72:75], v31 offset:18432
    ds_read_b128 v[76:79], v34 offset:18432
    ds_read_b128 v[80:83], v31 offset:19456
    v_mfma_f32_32x32x16_bf16 v[40:55], v[132:135], v[84:87], v[40:55]
    ds_read_b128 v[84:87], v34 offset:19456
    s_waitcnt lgkmcnt(7)
    v_mfma_f32_32x32x16_bf16 v[12:27], v[136:139], v[56:59], v[12:27]
    ds_read_b64_tr_b16 v[120:121], v28 offset:0
    ds_read_b64_tr_b16 v[122:123], v28 offset:512
    ds_read_b64_tr_b16 v[124:125], v28 offset:2048
    ds_read_b64_tr_b16 v[126:127], v28 offset:2560
    s_waitcnt lgkmcnt(10)
    v_mfma_f32_32x32x16_bf16 v[40:55], v[136:139], v[60:63], v[40:55]
    ds_read_b64_tr_b16 v[128:129], v28 offset:4096
    ds_read_b64_tr_b16 v[130:131], v28 offset:4608
    ds_read_b64_tr_b16 v[132:133], v28 offset:6144
    ds_read_b64_tr_b16 v[134:135], v28 offset:6656
    s_waitcnt lgkmcnt(13)
    v_mfma_f32_32x32x16_bf16 v[12:27], v[140:143], v[64:67], v[12:27]
    s_waitcnt lgkmcnt(12)
    v_mfma_f32_32x32x16_bf16 v[40:55], v[140:143], v[68:71], v[40:55]
    ds_read_b32 v8, v3 offset:64
    s_waitcnt lgkmcnt(12)
    v_mfma_f32_32x32x16_bf16 v[12:27], v[144:147], v[72:75], v[12:27]
    s_waitcnt lgkmcnt(0)
    v_cmp_eq_u32 s[70:71], 0, v8
    v_mfma_f32_32x32x16_bf16 v[40:55], v[144:147], v[76:79], v[40:55]
    s_cmp_eq_u64 s[70:71], 0
    s_cbranch_scc1 LDb_33
LDt_32:
    ds_read_b32 v8, v3 offset:64
    s_sub_u32 s64, s64, 1
    s_cbranch_scc1 END_Y
    s_waitcnt lgkmcnt(0)
    v_cmp_eq_u32 s[70:71], 0, v8
    s_nop 0
    s_cmp_lg_u64 s[70:71], 0
    s_cbranch_scc1 LDt_32
LDb_33:
    ds_read_b128 v[56:59], v31 offset:32768
    ds_read_b128 v[60:63], v34 offset:32768
    ds_read_b128 v[64:67], v31 offset:33792
    ds_read_b128 v[68:71], v34 offset:33792
    v_mfma_f32_32x32x16_bf16 v[12:27], v[148:151], v[80:83], v[12:27]
    ds_read_b128 v[72:75], v31 offset:34816
    ds_read_b128 v[76:79], v34 offset:34816
    ds_read_b128 v[80:83], v31 offset:35840
    v_mfma_f32_32x32x16_bf16 v[40:55], v[148:151], v[84:87], v[40:55]
    ds_read_b128 v[84:87], v34 offset:35840
    s_waitcnt lgkmcnt(7)
    v_mfma_f32_32x32x16_bf16 v[12:27], v[152:155], v[56:59], v[12:27]
    ds_read_b64_tr_b16 v[136:137], v28 offset:16384
    ds_read_b64_tr_b16 v[138:139], v28 offset:16896
    ds_read_b64_tr_b16 v[140:141], v28 offset:18432
    ds_read_b64_tr_b16 v[142:143], v28 offset:18944
    s_waitcnt lgkmcnt(10)
    v_mfma_f32_32x32x16_bf16 v[40:55], v[152:155], v[60:63], v[40:55]
    ds_read_b64_tr_b16 v[144:145], v28 offset:20480
    ds_read_b64_tr_b16 v[146:147], v28 offset:20992
    ds_read_b64_tr_b16 v[148:149], v28 offset:22528
    ds_read_b64_tr_b16 v[150:151], v28 offset:23040
    s_waitcnt lgkmcnt(13)
    v_mfma_f32_32x32x16_bf16 v[12:27], v[156:159], v[64:67], v[12:27]
    s_waitcnt lgkmcnt(12)
    v_mfma_f32_32x32x16_bf16 v[40:55], v[156:159], v[68:71], v[40:55]
    ds_read_b32 v8, v3 offset:80
    s_waitcnt lgkmcnt(12)
    v_mfma_f32_32x32x16_bf16 v[12:27], v[160:163], v[72:75], v[12:27]
    s_waitcnt lgkmcnt(0)
    v_cmp_eq_u32 s[70:71], 0, v8
    v_mfma_f32_32x32x16_bf16 v[40:55], v[160:163], v[76:79], v[40:55]
    s_cmp_eq_u64 s[70:71], 0
    s_cbranch_scc1 LDb_35
LDt_34:
    ds_read_b32 v8, v3 offset:80
    s_sub_u32 s64, s64, 1
    s_cbranch_scc1 END_Y
    s_waitcnt lgkmcnt(0)
    v_cmp_eq_u32 s[70:71], 0, v8
    s_nop 0
    s_cmp_lg_u64 s[70:71], 0
    s_cbranch_scc1 LDt_34
LDb_35:
    ds_read_b128 v[56:59], v30 offset:32768
    ds_read_b128 v[60:63], v33 offset:32768
    ds_read_b128 v[64:67], v30 offset:33792
    ds_read_b128 v[68:71], v33 offset:33792
    v_mfma_f32_32x32x16_bf16 v[12:27], v[164:167], v[80:83], v[12:27]
    ds_read_b128 v[72:75], v30 offset:34816
    ds_read_b128 v[76:79], v33 offset:34816
    ds_read_b128 v[80:83], v30 offset:35840
    v_mfma_f32_32x32x16_bf16 v[40:55], v[164:167], v[84:87], v[40:55]
    ds_read_b128 v[84:87], v33 offset:35840
    s_waitcnt lgkmcnt(7)
    v_mfma_f32_32x32x16_bf16 v[12:27], v[168:171], v[56:59], v[12:27]
    s_waitcnt lgkmcnt(6)
    v_mfma_f32_32x32x16_bf16 v[40:55], v[168:171], v[60:63], v[40:55]
    s_waitcnt lgkmcnt(5)
    v_mfma_f32_32x32x16_bf16 v[12:27], v[172:175], v[64:67], v[12:27]
    s_waitcnt lgkmcnt(4)
    v_mfma_f32_32x32x16_bf16 v[40:55], v[172:175], v[68:71], v[40:55]
    ds_read_b32 v8, v3 offset:96
    s_waitcnt lgkmcnt(4)
    v_mfma_f32_32x32x16_bf16 v[12:27], v[176:179], v[72:75], v[12:27]
    s_waitcnt lgkmcnt(0)
    v_cmp_eq_u32 s[70:71], 0, v8
    v_mov_b32 v6, 6
    ds_write_b32 v4, v6
    v_mfma_f32_32x32x16_bf16 v[40:55], v[176:179], v[76:79], v[40:55]
    s_cmp_eq_u64 s[70:71], 0
    s_cbranch_scc1 LDb_37
LDt_36:
    ds_read_b32 v8, v3 offset:96
    s_sub_u32 s64, s64, 1
    s_cbranch_scc1 END_Y
    s_waitcnt lgkmcnt(0)
    v_cmp_eq_u32 s[70:71], 0, v8
    s_nop 0
    s_cmp_lg_u64 s[70:71], 0
    s_cbranch_scc1 LDt_36
LDb_37:
    ds_read_b128 v[56:59], v30 offset:49152
    ds_read_b128 v[60:63], v33 offset:49152
    ds_read_b128 v[64:67], v30 offset:50176
    ds_read_b128 v[68:71], v33 offset:50176
    v_mfma_f32_32x32x16_bf16 v[12:27], v[180:183], v[80:83], v[12:27]
    ds_read_b128 v[72:75], v30 offset:51200
    ds_read_b128 v[76:79], v33 offset:51200
    ds_read_b128 v[80:83], v30 offset:52224
    v_mfma_f32_32x32x16_bf16 v[40:55], v[180:183], v[84:87], v[40:55]
    ds_read_b128 v[84:87], v33 offset:52224
    s_waitcnt lgkmcnt(7)
    v_mfma_f32_32x32x16_bf16 v[12:27], v[184:187], v[56:59], v[12:27]
    s_waitcnt lgkmcnt(6)
    v_mfma_f32_32x32x16_bf16 v[40:55], v[184:187], v[60:63], v[40:55]
    s_waitcnt lgkmcnt(5)
    v_mfma_f32_32x32x16_bf16 v[12:27], v[188:191], v[64:67], v[12:27]
    s_waitcnt lgkmcnt(4)
    v_mfma_f32_32x32x16_bf16 v[40:55], v[188:191], v[68:71], v[40:55]
    ds_read_b32 v8, v3 offset:112
    s_waitcnt lgkmcnt(4)
    v_mfma_f32_32x32x16_bf16 v[12:27], v[192:195], v[72:75], v[12:27]
    s_waitcnt lgkmcnt(0)
    v_cmp_eq_u32 s[70:71], 0, v8
    v_mfma_f32_32x32x16_bf16 v[40:55], v[192:195], v[76:79], v[40:55]
    s_cmp_eq_u64 s[70:71], 0
    s_cbranch_scc1 LDb_39
LDt_38:
    ds_read_b32 v8, v3 offset:112
    s_sub_u32 s64, s64, 1
    s_cbranch_scc1 END_Y
    s_waitcnt lgkmcnt(0)
    v_cmp_eq_u32 s[70:71], 0, v8
    s_nop 0
    s_cmp_lg_u64 s[70:71], 0
    s_cbranch_scc1 LDt_38
LDb_39:
    ds_read_b128 v[56:59], v31 offset:57344
    ds_read_b128 v[60:63], v34 offset:57344
    ds_read_b128 v[64:67], v31 offset:58368
    ds_read_b128 v[68:71], v34 offset:58368
    v_mfma_f32_32x32x16_bf16 v[12:27], v[196:199], v[80:83], v[12:27]
    ds_read_b128 v[72:75], v31 offset:59392
    ds_read_b128 v[76:79], v34 offset:59392
    ds_read_b128 v[80:83], v31 offset:60416
    v_mfma_f32_32x32x16_bf16 v[40:55], v[196:199], v[84:87], v[40:55]
    ds_read_b128 v[84:87], v34 offset:60416
    s_waitcnt lgkmcnt(7)
    v_mfma_f32_32x32x16_bf16 v[12:27], v[200:203], v[56:59], v[12:27]
    s_waitcnt lgkmcnt(6)
    v_mfma_f32_32x32x16_bf16 v[40:55], v[200:203], v[60:63], v[40:55]
    s_waitcnt lgkmcnt(5)
    v_mfma_f32_32x32x16_bf16 v[12:27], v[204:207], v[64:67], v[12:27]
    s_waitcnt lgkmcnt(4)
    v_mfma_f32_32x32x16_bf16 v[40:55], v[204:207], v[68:71], v[40:55]
    ds_read_b32 v8, v3 offset:512
    s_waitcnt lgkmcnt(4)
    v_mfma_f32_32x32x16_bf16 v[12:27], v[208:211], v[72:75], v[12:27]
    s_waitcnt lgkmcnt(0)
    v_cmp_eq_u32 s[70:71], 0, v8
    v_mfma_f32_32x32x16_bf16 v[40:55], v[208:211], v[76:79], v[40:55]
    s_cmp_eq_u64 s[70:71], 0
    s_cbranch_scc1 LDb_41
LDt_40:
    ds_read_b32 v8, v3 offset:512
    s_sub_u32 s64, s64, 1
    s_cbranch_scc1 END_Y
    s_waitcnt lgkmcnt(0)
    v_cmp_eq_u32 s[70:71], 0, v8
    s_nop 0
    s_cmp_lg_u64 s[70:71], 0
    s_cbranch_scc1 LDt_40
LDb_41:
    ds_read_b128 v[56:59], v31 offset:0
    ds_read_b128 v[60:63], v34 offset:0
    ds_read_b128 v[64:67], v31 offset:1024
    ds_read_b128 v[68:71], v34 offset:1024
    v_mfma_f32_32x32x16_bf16 v[12:27], v[212:215], v[80:83], v[12:27]
    ds_read_b128 v[72:75], v31 offset:2048
    ds_read_b128 v[76:79], v34 offset:2048
    ds_read_b128 v[80:83], v31 offset:3072
    v_mfma_f32_32x32x16_bf16 v[40:55], v[212:215], v[84:87], v[40:55]
    ds_read_b128 v[84:87], v34 offset:3072
    s_waitcnt lgkmcnt(7)
    v_mfma_f32_32x32x16_bf16 v[12:27], v[216:219], v[56:59], v[12:27]
    s_waitcnt lgkmcnt(6)
    v_mfma_f32_32x32x16_bf16 v[40:55], v[216:219], v[60:63], v[40:55]
    s_waitcnt lgkmcnt(5)
    v_mfma_f32_32x32x16_bf16 v[12:27], v[220:223], v[64:67], v[12:27]
    s_waitcnt lgkmcnt(4)
    v_mfma_f32_32x32x16_bf16 v[40:55], v[220:223], v[68:71], v[40:55]
    ds_read_b32 v8, v3 offset:528
    s_waitcnt lgkmcnt(4)
    v_mfma_f32_32x32x16_bf16 v[12:27], v[224:227], v[72:75], v[12:27]
    s_waitcnt lgkmcnt(0)
    v_cmp_eq_u32 s[70:71], 0, v8
    v_mfma_f32_32x32x16_bf16 v[40:55], v[224:227], v[76:79], v[40:55]
    s_cmp_eq_u64 s[70:71], 0
    s_cbranch_scc1 LDb_43
LDt_42:
    ds_read_b32 v8, v3 offset:528
    s_sub_u32 s64, s64, 1
    s_cbranch_scc1 END_Y
    s_waitcnt lgkmcnt(0)
    v_cmp_eq_u32 s[70:71], 0, v8
    s_nop 0
    s_cmp_lg_u64 s[70:71], 0
    s_cbranch_scc1 LDt_42
LDb_43:
    ds_read_b128 v[56:59], v32 offset:8192
    ds_read_b128 v[60:63], v35 offset:8192
    ds_read_b128 v[64:67], v32 offset:9216
    ds_read_b128 v[68:71], v35 offset:9216
    v_mfma_f32_32x32x16_bf16 v[12:27], v[228:231], v[80:83], v[12:27]
    ds_read_b128 v[72:75], v32 offset:10240
    ds_read_b128 v[76:79], v35 offset:10240
    ds_read_b128 v[80:83], v32 offset:11264
    v_mfma_f32_32x32x16_bf16 v[40:55], v[228:231], v[84:87], v[40:55]
    ds_read_b128 v[84:87], v35 offset:11264
    s_waitcnt lgkmcnt(7)
    v_mfma_f32_32x32x16_bf16 v[12:27], v[232:235], v[56:59], v[12:27]
    s_waitcnt lgkmcnt(6)
    v_mfma_f32_32x32x16_bf16 v[40:55], v[232:235], v[60:63], v[40:55]
    s_waitcnt lgkmcnt(5)
    v_mfma_f32_32x32x16_bf16 v[12:27], v[236:239], v[64:67], v[12:27]
    s_waitcnt lgkmcnt(4)
    v_mfma_f32_32x32x16_bf16 v[40:55], v[236:239], v[68:71], v[40:55]
    ds_read_b32 v8, v3 offset:544
    s_waitcnt lgkmcnt(4)
    v_mfma_f32_32x32x16_bf16 v[12:27], v[240:243], v[72:75], v[12:27]
    s_waitcnt lgkmcnt(0)
    v_cmp_eq_u32 s[70:71], 0, v8
    v_mfma_f32_32x32x16_bf16 v[40:55], v[240:243], v[76:79], v[40:55]
    s_cmp_eq_u64 s[70:71], 0
    s_cbranch_scc1 LDb_45
LDt_44:
    ds_read_b32 v8, v3 offset:544
    s_sub_u32 s64, s64, 1
    s_cbranch_scc1 END_Y
    s_waitcnt lgkmcnt(0)
    v_cmp_eq_u32 s[70:71], 0, v8
    s_nop 0
    s_cmp_lg_u64 s[70:71], 0
    s_cbranch_scc1 LDt_44
LDb_45:
    ds_read_b128 v[56:59], v31 offset:16384
    ds_read_b128 v[60:63], v34 offset:16384
    ds_read_b128 v[64:67], v31 offset:17408
    ds_read_b128 v[68:71], v34 offset:17408
    v_mfma_f32_32x32x16_bf16 v[12:27], v[244:247], v[80:83], v[12:27]
    ds_read_b128 v[72:75], v31 offset:18432
    ds_read_b128 v[76:79], v34 offset:18432
    ds_read_b128 v[80:83], v31 offset:19456
    v_mfma_f32_32x32x16_bf16 v[40:55], v[244:247], v[84:87], v[40:55]
    ds_read_b128 v[84:87], v34 offset:19456
    s_waitcnt lgkmcnt(7)
    v_mfma_f32_32x32x16_bf16 v[12:27], v[88:91], v[56:59], v[12:27]
    v_add_u32 v184, s60, v2
    ds_read_b128 v[168:171], v184
    ds_read_b128 v[172:175], v184 offset:1024
    s_waitcnt lgkmcnt(8)
    v_mfma_f32_32x32x16_bf16 v[40:55], v[88:91], v[60:63], v[40:55]
    v_and_b32 v251, 31, v1
    v_lshl_add_u32 v251, v251, 2, s61
    s_waitcnt lgkmcnt(7)
    v_mfma_f32_32x32x16_bf16 v[12:27], v[92:95], v[64:67], v[12:27]
    s_waitcnt lgkmcnt(6)
    v_mfma_f32_32x32x16_bf16 v[40:55], v[92:95], v[68:71], v[40:55]
    ds_read_b32 v8, v3 offset:560
    s_waitcnt lgkmcnt(6)
    v_mfma_f32_32x32x16_bf16 v[12:27], v[96:99], v[72:75], v[12:27]
    s_waitcnt lgkmcnt(0)
    v_cmp_eq_u32 s[70:71], 0, v8
    v_mfma_f32_32x32x16_bf16 v[40:55], v[96:99], v[76:79], v[40:55]
    s_cmp_eq_u64 s[70:71], 0
    s_cbranch_scc1 LDb_47
LDt_46:
    ds_read_b32 v8, v3 offset:560
    s_sub_u32 s64, s64, 1
    s_cbranch_scc1 END_Y
    s_waitcnt lgkmcnt(0)
    v_cmp_eq_u32 s[70:71], 0, v8
    s_nop 0
    s_cmp_lg_u64 s[70:71], 0
    s_cbranch_scc1 LDt_46
LDb_47:
    ds_read_b128 v[56:59], v30 offset:0
    ds_read_b128 v[60:63], v33 offset:0
    ds_read_b128 v[64:67], v30 offset:1024
    ds_read_b128 v[68:71], v33 offset:1024
    v_mfma_f32_32x32x16_bf16 v[12:27], v[100:103], v[80:83], v[12:27]
    ds_read_b128 v[72:75], v30 offset:2048
    ds_read_b128 v[76:79], v33 offset:2048
    ds_read_b128 v[80:83], v30 offset:3072
    v_mfma_f32_32x32x16_bf16 v[40:55], v[100:103], v[84:87], v[40:55]
    ds_read_b128 v[84:87], v33 offset:3072
    s_waitcnt lgkmcnt(7)
    v_mfma_f32_32x32x16_bf16 v[12:27], v[104:107], v[56:59], v[12:27]
    v_lshlrev_b32 v184, 16, v168
    v_and_b32 v185, 0xffff0000, v168
    v_lshlrev_b32 v186, 16, v169
    s_waitcnt lgkmcnt(6)
    v_mfma_f32_32x32x16_bf16 v[40:55], v[104:107], v[60:63], v[40:55]
    v_and_b32 v187, 0xffff0000, v169
    v_lshlrev_b32 v188, 16, v170
    v_and_b32 v189, 0xffff0000, v170
    s_waitcnt lgkmcnt(5)
    v_mfma_f32_32x32x16_bf16 v[12:27], v[108:111], v[64:67], v[12:27]
    v_lshlrev_b32 v190, 16, v171
    v_and_b32 v191, 0xffff0000, v171
    v_lshlrev_b32 v192, 16, v172
    s_waitcnt lgkmcnt(4)
    v_mfma_f32_32x32x16_bf16 v[40:55], v[108:111], v[68:71], v[40:55]
    ds_read_b32 v8, v3 offset:576
    s_waitcnt lgkmcnt(4)
    v_mfma_f32_32x32x16_bf16 v[12:27], v[112:115], v[72:75], v[12:27]
    s_waitcnt lgkmcnt(0)
    v_cmp_eq_u32 s[70:71], 0, v8
    v_mfma_f32_32x32x16_bf16 v[40:55], v[112:115], v[76:79], v[40:55]
    s_cmp_eq_u64 s[70:71], 0
    s_cbranch_scc1 LDb_49
LDt_48:
    ds_read_b32 v8, v3 offset:576
    s_sub_u32 s64, s64, 1
    s_cbranch_scc1 END_Y
    s_waitcnt lgkmcnt(0)
    v_cmp_eq_u32 s[70:71], 0, v8
    s_nop 0
    s_cmp_lg_u64 s[70:71], 0
    s_cbranch_scc1 LDt_48
LDb_49:
    ds_read_b128 v[56:59], v31 offset:32768
    ds_read_b128 v[60:63], v34 offset:32768
    ds_read_b128 v[64:67], v31 offset:33792
    ds_read_b128 v[68:71], v34 offset:33792
    v_mfma_f32_32x32x16_bf16 v[12:27], v[116:119], v[80:83], v[12:27]
    ds_read_b128 v[72:75], v31 offset:34816
    ds_read_b128 v[76:79], v34 offset:34816
    ds_read_b128 v[80:83], v31 offset:35840
    v_mfma_f32_32x32x16_bf16 v[40:55], v[116:119], v[84:87], v[40:55]
    ds_read_b128 v[84:87], v34 offset:35840
    s_waitcnt lgkmcnt(7)
    v_mfma_f32_32x32x16_bf16 v[12:27], v[120:123], v[56:59], v[12:27]
    v_and_b32 v193, 0xffff0000, v172
    v_lshlrev_b32 v194, 16, v173
    v_and_b32 v195, 0xffff0000, v173
    s_waitcnt lgkmcnt(6)
    v_mfma_f32_32x32x16_bf16 v[40:55], v[120:123], v[60:63], v[40:55]
    v_lshlrev_b32 v196, 16, v174
    v_and_b32 v197, 0xffff0000, v174
    v_lshlrev_b32 v198, 16, v175
    s_waitcnt lgkmcnt(5)
    v_mfma_f32_32x32x16_bf16 v[12:27], v[124:127], v[64:67], v[12:27]
    v_and_b32 v199, 0xffff0000, v175
    s_waitcnt lgkmcnt(4)
    v_mfma_f32_32x32x16_bf16 v[40:55], v[124:127], v[68:71], v[40:55]
    ds_read_b32 v8, v3 offset:592
    s_waitcnt lgkmcnt(4)
    v_mfma_f32_32x32x16_bf16 v[12:27], v[128:131], v[72:75], v[12:27]
    s_waitcnt lgkmcnt(0)
    v_cmp_eq_u32 s[70:71], 0, v8
    v_mfma_f32_32x32x16_bf16 v[40:55], v[128:131], v[76:79], v[40:55]
    s_cmp_eq_u64 s[70:71], 0
    s_cbranch_scc1 LDb_51
LDt_50:
    ds_read_b32 v8, v3 offset:592
    s_sub_u32 s64, s64, 1
    s_cbranch_scc1 END_Y
    s_waitcnt lgkmcnt(0)
    v_cmp_eq_u32 s[70:71], 0, v8
    s_nop 0
    s_cmp_lg_u64 s[70:71], 0
    s_cbranch_scc1 LDt_50
LDb_51:
    ds_read_b128 v[56:59], v30 offset:16384
    ds_read_b128 v[60:63], v33 offset:16384
    ds_read_b128 v[64:67], v30 offset:17408
    ds_read_b128 v[68:71], v33 offset:17408
    v_mfma_f32_32x32x16_bf16 v[12:27], v[132:135], v[80:83], v[12:27]
    ds_read_b128 v[72:75], v30 offset:18432
    ds_read_b128 v[76:79], v33 offset:18432
    ds_read_b128 v[80:83], v30 offset:19456
    v_mfma_f32_32x32x16_bf16 v[40:55], v[132:135], v[84:87], v[40:55]
    ds_read_b128 v[84:87], v33 offset:19456
    s_waitcnt lgkmcnt(6)
    v_mfma_f32_32x32x16_bf16 v[40:55], v[136:139], v[60:63], v[40:55]
    s_xor_b32 s3, s44, 2
    s_lshl_b32 s3, s3, 12
    s_add_u32 s3, s3, 32768
    v_add_u32 v3, s3, v2
    s_waitcnt lgkmcnt(4)
    v_mfma_f32_32x32x16_bf16 v[40:55], v[140:143], v[68:71], v[40:55]
    s_lshl_b32 s3, s44, 12
    s_add_u32 s3, s3, 32768
    v_add_u32 v4, s3, v2
    s_waitcnt lgkmcnt(2)
    v_mfma_f32_32x32x16_bf16 v[40:55], v[144:147], v[76:79], v[40:55]
    s_waitcnt lgkmcnt(0)
    v_mfma_f32_32x32x16_bf16 v[40:55], v[148:151], v[84:87], v[40:55]
    v_mfma_f32_32x32x16_bf16 v[12:27], v[136:139], v[56:59], v[12:27]
    s_lshr_b32 s3, s44, 1
    s_add_u32 s3, s3, s54
    s_mul_i32 s55, s3, 28672
    s_lshl_b32 s3, s53, 7
    s_add_u32 s55, s55, s3
    v_mfma_f32_32x32x16_bf16 v[12:27], v[140:143], v[64:67], v[12:27]
    s_and_b32 s3, s44, 1
    s_mul_i32 s3, s3, 14336
    s_add_u32 s55, s55, s3
    s_add_u32 s56, s55, 7168
    s_nop 0
    ds_write_b128 v3, v[40:43] offset:0
    ds_write_b128 v3, v[44:47] offset:1024
    v_mfma_f32_32x32x16_bf16 v[12:27], v[144:147], v[72:75], v[12:27]
    ds_write_b128 v3, v[48:51] offset:2048
    ds_write_b128 v3, v[52:55] offset:3072
    v_mfma_f32_32x32x16_bf16 v[12:27], v[148:151], v[80:83], v[12:27]
    s_waitcnt lgkmcnt(0)
    s_barrier
    ds_read_b32 v251, v251
    ds_read_b128 v[40:43], v4 offset:0
    ds_read_b128 v[44:47], v4 offset:1024
    ds_read_b128 v[48:51], v4 offset:2048
    ds_read_b128 v[52:55], v4 offset:3072
    s_waitcnt lgkmcnt(3)
    s_nop 3
    v_pk_add_f32 v[12:13], v[12:13], v[40:41]
    v_fma_f32 v12, v12, v251, v184
    v_fma_f32 v13, v13, v251, v185
    v_cvt_pk_bf16_f32 v56, v12, v13
    v_pk_add_f32 v[14:15], v[14:15], v[42:43]
    v_fma_f32 v14, v14, v251, v186
    v_fma_f32 v15, v15, v251, v187
    v_cvt_pk_bf16_f32 v57, v14, v15
    s_waitcnt lgkmcnt(2)
    v_pk_add_f32 v[16:17], v[16:17], v[44:45]
    v_fma_f32 v16, v16, v251, v188
    v_fma_f32 v17, v17, v251, v189
    v_cvt_pk_bf16_f32 v58, v16, v17
    v_pk_add_f32 v[18:19], v[18:19], v[46:47]
    v_fma_f32 v18, v18, v251, v190
    v_fma_f32 v19, v19, v251, v191
    v_cvt_pk_bf16_f32 v59, v18, v19
    ds_write_b128 v248, v[56:59]
    s_waitcnt lgkmcnt(2)
    v_pk_add_f32 v[20:21], v[20:21], v[48:49]
    v_fma_f32 v20, v20, v251, v192
    v_fma_f32 v21, v21, v251, v193
    v_cvt_pk_bf16_f32 v60, v20, v21
    v_pk_add_f32 v[22:23], v[22:23], v[50:51]
    v_fma_f32 v22, v22, v251, v194
    v_fma_f32 v23, v23, v251, v195
    v_cvt_pk_bf16_f32 v61, v22, v23
    s_waitcnt lgkmcnt(1)
    v_pk_add_f32 v[24:25], v[24:25], v[52:53]
    v_fma_f32 v24, v24, v251, v196
    v_fma_f32 v25, v25, v251, v197
    v_cvt_pk_bf16_f32 v62, v24, v25
    v_pk_add_f32 v[26:27], v[26:27], v[54:55]
    v_fma_f32 v26, v26, v251, v198
    v_fma_f32 v27, v27, v251, v199
    v_cvt_pk_bf16_f32 v63, v26, v27
    ds_write_b128 v249, v[60:63]
    s_waitcnt lgkmcnt(0)
    s_barrier
    ds_read_b128 v[64:67], v250
    ds_read_b128 v[68:71], v250 offset:1024
    s_waitcnt lgkmcnt(1)
    buffer_store_dwordx4 v[64:67], v36, s[32:35], s55 offen
    s_waitcnt lgkmcnt(0)
    buffer_store_dwordx4 v[68:71], v36, s[32:35], s56 offen
END_Y:
    s_endpgm
.p2align 12
Y_PREF:
    v_lshlrev_b32 v3, 7, v1
    s_sub_u32 s55, s46, 28
    s_lshl_b32 s55, s55, 2
    s_add_u32 s55, s55, s44
    v_lshrrev_b32 v4, 3, v1
    v_mul_u32_u24 v5, 3584, v4
    v_and_b32 v4, 7, v1
    v_min_u32 v4, 6, v4
    v_lshl_add_u32 v5, v4, 7, v5
    s_add_u32 s56, s55, 24
    s_mul_i32 s56, s56, 28672
    s_mul_i32 s57, s52, 896
    s_add_u32 s56, s56, s57
    s_bitcmp1_b32 s45, 2
    s_cbranch_scc1 PGG
    buffer_load_dword v30, v5, s[24:27], s56 offen
    s_add_u32 s56, s56, 458752
    buffer_load_dword v31, v5, s[24:27], s56 offen
    s_add_u32 s56, s56, 458752
    s_branch PGE
PGG:
    buffer_load_dword v34, v5, s[20:23], s56 offen
    s_add_u32 s56, s56, 458752
    buffer_load_dword v35, v5, s[20:23], s56 offen
    s_add_u32 s56, s56, 458752
PGE:
    s_waitcnt vmcnt(2) lgkmcnt(0)
    s_barrier
    s_barrier
    s_mul_i32 s56, s55, 1338
    s_lshr_b32 s56, s56, 16
    s_mul_i32 s57, s56, 49
    s_sub_u32 s57, s55, s57
    s_cmp_ge_u32 s56, 1
    s_cselect_b32 s58, 0, 0
    s_add_u32 s56, s56, s58
    s_sub_u32 s56, s52, s56
    s_and_b32 s56, s56, 3
    s_mul_i32 s56, s56, 49
    s_add_u32 s56, s56, s57
    s_lshl_b32 s56, s56, 13
    buffer_load_dword v40, v3, s[28:31], s56 offen
    s_add_u32 s55, s55, 16
    s_barrier
    s_mul_i32 s56, s55, 1338
    s_lshr_b32 s56, s56, 16
    s_mul_i32 s57, s56, 49
    s_sub_u32 s57, s55, s57
    s_cmp_ge_u32 s56, 1
    s_cselect_b32 s58, 0, 0
    s_add_u32 s56, s56, s58
    s_sub_u32 s56, s52, s56
    s_and_b32 s56, s56, 3
    s_mul_i32 s56, s56, 49
    s_add_u32 s56, s56, s57
    s_lshl_b32 s56, s56, 13
    buffer_load_dword v41, v3, s[28:31], s56 offen
    s_add_u32 s55, s55, 16
    s_mul_i32 s56, s55, 1338
    s_lshr_b32 s56, s56, 16
    s_mul_i32 s57, s56, 49
    s_sub_u32 s57, s55, s57
    s_cmp_ge_u32 s56, 1
    s_cselect_b32 s58, 0, 0
    s_add_u32 s56, s56, s58
    s_sub_u32 s56, s52, s56
    s_and_b32 s56, s56, 3
    s_mul_i32 s56, s56, 49
    s_add_u32 s56, s56, s57
    s_lshl_b32 s56, s56, 13
    buffer_load_dword v42, v3, s[28:31], s56 offen
    s_add_u32 s55, s55, 16
    s_mul_i32 s56, s55, 1338
    s_lshr_b32 s56, s56, 16
    s_mul_i32 s57, s56, 49
    s_sub_u32 s57, s55, s57
    s_cmp_ge_u32 s56, 1
    s_cselect_b32 s58, 0, 0
    s_add_u32 s56, s56, s58
    s_sub_u32 s56, s52, s56
    s_and_b32 s56, s56, 3
    s_mul_i32 s56, s56, 49
    s_add_u32 s56, s56, s57
    s_lshl_b32 s56, s56, 13
    buffer_load_dword v43, v3, s[28:31], s56 offen
    s_add_u32 s55, s55, 16
    s_mul_i32 s56, s55, 1338
    s_lshr_b32 s56, s56, 16
    s_mul_i32 s57, s56, 49
    s_sub_u32 s57, s55, s57
    s_cmp_ge_u32 s56, 1
    s_cselect_b32 s58, 0, 0
    s_add_u32 s56, s56, s58
    s_sub_u32 s56, s52, s56
    s_and_b32 s56, s56, 3
    s_mul_i32 s56, s56, 49
    s_add_u32 s56, s56, s57
    s_lshl_b32 s56, s56, 13
    buffer_load_dword v44, v3, s[28:31], s56 offen
    s_add_u32 s55, s55, 16
    s_mul_i32 s56, s55, 1338
    s_lshr_b32 s56, s56, 16
    s_mul_i32 s57, s56, 49
    s_sub_u32 s57, s55, s57
    s_cmp_ge_u32 s56, 1
    s_cselect_b32 s58, 0, 0
    s_add_u32 s56, s56, s58
    s_sub_u32 s56, s52, s56
    s_and_b32 s56, s56, 3
    s_mul_i32 s56, s56, 49
    s_add_u32 s56, s56, s57
    s_lshl_b32 s56, s56, 13
    buffer_load_dword v45, v3, s[28:31], s56 offen
    s_add_u32 s55, s55, 16
    s_mul_i32 s56, s55, 1338
    s_lshr_b32 s56, s56, 16
    s_mul_i32 s57, s56, 49
    s_sub_u32 s57, s55, s57
    s_cmp_ge_u32 s56, 1
    s_cselect_b32 s58, 0, 0
    s_add_u32 s56, s56, s58
    s_sub_u32 s56, s52, s56
    s_and_b32 s56, s56, 3
    s_mul_i32 s56, s56, 49
    s_add_u32 s56, s56, s57
    s_lshl_b32 s56, s56, 13
    buffer_load_dword v46, v3, s[28:31], s56 offen
    s_add_u32 s55, s55, 16
    s_mul_i32 s56, s55, 1338
    s_lshr_b32 s56, s56, 16
    s_mul_i32 s57, s56, 49
    s_sub_u32 s57, s55, s57
    s_cmp_ge_u32 s56, 1
    s_cselect_b32 s58, 0, 0
    s_add_u32 s56, s56, s58
    s_sub_u32 s56, s52, s56
    s_and_b32 s56, s56, 3
    s_mul_i32 s56, s56, 49
    s_add_u32 s56, s56, s57
    s_lshl_b32 s56, s56, 13
    buffer_load_dword v47, v3, s[28:31], s56 offen
    s_add_u32 s55, s55, 16
    s_mul_i32 s56, s55, 1338
    s_lshr_b32 s56, s56, 16
    s_mul_i32 s57, s56, 49
    s_sub_u32 s57, s55, s57
    s_cmp_ge_u32 s56, 1
    s_cselect_b32 s58, 0, 0
    s_add_u32 s56, s56, s58
    s_sub_u32 s56, s52, s56
    s_and_b32 s56, s56, 3
    s_mul_i32 s56, s56, 49
    s_add_u32 s56, s56, s57
    s_lshl_b32 s56, s56, 13
    buffer_load_dword v48, v3, s[28:31], s56 offen
    s_add_u32 s55, s55, 16
    s_mul_i32 s56, s55, 1338
    s_lshr_b32 s56, s56, 16
    s_mul_i32 s57, s56, 49
    s_sub_u32 s57, s55, s57
    s_cmp_ge_u32 s56, 1
    s_cselect_b32 s58, 0, 0
    s_add_u32 s56, s56, s58
    s_sub_u32 s56, s52, s56
    s_and_b32 s56, s56, 3
    s_mul_i32 s56, s56, 49
    s_add_u32 s56, s56, s57
    s_lshl_b32 s56, s56, 13
    buffer_load_dword v49, v3, s[28:31], s56 offen
    s_add_u32 s55, s55, 16
    s_mul_i32 s56, s55, 1338
    s_lshr_b32 s56, s56, 16
    s_mul_i32 s57, s56, 49
    s_sub_u32 s57, s55, s57
    s_cmp_ge_u32 s56, 1
    s_cselect_b32 s58, 0, 0
    s_add_u32 s56, s56, s58
    s_sub_u32 s56, s52, s56
    s_and_b32 s56, s56, 3
    s_mul_i32 s56, s56, 49
    s_add_u32 s56, s56, s57
    s_lshl_b32 s56, s56, 13
    buffer_load_dword v50, v3, s[28:31], s56 offen
    s_add_u32 s55, s55, 16
    s_mul_i32 s56, s55, 1338
    s_lshr_b32 s56, s56, 16
    s_mul_i32 s57, s56, 49
    s_sub_u32 s57, s55, s57
    s_cmp_ge_u32 s56, 1
    s_cselect_b32 s58, 0, 0
    s_add_u32 s56, s56, s58
    s_sub_u32 s56, s52, s56
    s_and_b32 s56, s56, 3
    s_mul_i32 s56, s56, 49
    s_add_u32 s56, s56, s57
    s_lshl_b32 s56, s56, 13
    buffer_load_dword v51, v3, s[28:31], s56 offen
    s_add_u32 s55, s55, 16
    s_mul_i32 s56, s55, 1338
    s_lshr_b32 s56, s56, 16
    s_mul_i32 s57, s56, 49
    s_sub_u32 s57, s55, s57
    s_cmp_ge_u32 s56, 1
    s_cselect_b32 s58, 0, 0
    s_add_u32 s56, s56, s58
    s_sub_u32 s56, s52, s56
    s_and_b32 s56, s56, 3
    s_mul_i32 s56, s56, 49
    s_add_u32 s56, s56, s57
    s_lshl_b32 s56, s56, 13
    buffer_load_dword v52, v3, s[28:31], s56 offen
    s_add_u32 s55, s55, 16
    s_waitcnt vmcnt(0)
END_P:
    s_endpgm
.p2align 12
ROLE_X:
    v_lshlrev_b32 v3, 2, v1
    v_and_b32 v3, 127, v3
    s_lshl_b32 s3, s44, 9
    s_add_u32 s3, s3, 162176
    v_add_u32 v3, s3, v3
    v_mov_b32 v4, 0
    ds_write_b32 v3, v4
    v_lshlrev_b32 v7, 7, v1
    s_cmp_eq_u32 s44, 1
    s_cbranch_scc1 PT_55
    s_cmp_eq_u32 s44, 2
    s_cbranch_scc1 PT_56
    s_cmp_eq_u32 s44, 3
    s_cbranch_scc1 PT_57
    s_mul_i32 s3, s48, 896
    s_mul_i32 s4, s49, 8960
    s_add_u32 s3, s3, s4
    s_max_u32 s3, s3, 14336
    s_sub_u32 s3, s3, 14336
    s_waitcnt lgkmcnt(0)
    buffer_load_dword v31, v7, s[8:11], s3 offen
    s_cmp_lg_u32 s2, 0
    s_cbranch_scc1 PTend_54
    s_mov_b64 exec, 1
    v_mov_b32 v5, 0
    s_mov_b32 s3, 13107200
    buffer_load_dword v24, v5, s[36:39], s3 offen sc1
    s_mov_b32 s4, 1664525
    s_waitcnt vmcnt(0)
    v_mul_lo_u32 v24, v24, s4
    v_add_u32 v24, 1013904223, v24
    v_mov_b32 v25, 1
    buffer_store_dwordx2 v[24:25], v5, s[40:43], 0 offen sc1
    buffer_store_dword v24, v5, s[36:39], s3 offen sc1
    s_mov_b64 exec, -1
    s_branch PTend_54
PT_55:
    s_getpc_b64 s[6:7]
PCREF:
    s_sub_u32 s6, s6, PCREF-sequential_preLN__sliding_local_dilated__glu_gated_reglu__prompt_kernel
    s_subb_u32 s7, s7, 0
    s_lshl_b32 s3, s46, 11
    s_cmp_ge_u32 s3, KEND-sequential_preLN__sliding_local_dilated__glu_gated_reglu__prompt_kernel
    s_cbranch_scc1 PTend_54
    v_add_u32 v26, s3, v7
    v_min_u32 v26, KEND-sequential_preLN__sliding_local_dilated__glu_gated_reglu__prompt_kernel-4, v26
    v_mov_b32 v27, s7
    v_add_co_u32 v26, vcc, s6, v26
    s_nop 1
    v_addc_co_u32 v27, vcc, 0, v27, vcc
    s_mov_b64 exec, 0xffff
    global_load_dword v28, v[26:27], off
    s_mov_b64 exec, -1
    s_branch PTend_54
PT_56:
    v_lshlrev_b32 v26, 21, v1
    s_mov_b32 s3, 32640
    s_mov_b64 exec, 0x3f
    s_waitcnt vmcnt(0) lgkmcnt(0)
    buffer_load_dword v28, v26, s[36:39], s3 offen sc1
    s_mov_b64 exec, 1
    buffer_load_dword v29, v26, s[32:35], 0 offen sc1
    s_mov_b64 exec, -1
    s_branch PTend_54
PT_57:
    s_lshl_b32 s3, s54, 9
    s_add_u32 s3, s3, 12582912
    s_mov_b64 exec, 0xff
    s_waitcnt vmcnt(0) lgkmcnt(0)
    buffer_load_dword v28, v7, s[36:39], s3 offen sc1
    s_add_u32 s3, s3, 32768
    buffer_load_dword v27, v7, s[36:39], s3 offen sc1
    s_add_u32 s3, s3, 65536
    buffer_load_dword v26, v7, s[36:39], s3 offen sc1
    s_lshl_b32 s3, s50, 12
    s_add_u32 s3, s3, 12648448
    s_mov_b64 exec, 0x7f7f7f7f
    buffer_load_dword v29, v7, s[36:39], s3 offen sc1
    s_lshl_b32 s3, s54, 11
    s_add_u32 s3, s3, 12713984
    s_mov_b64 exec, 0xfffffff
    buffer_load_dword v30, v7, s[36:39], s3 offen sc1
    s_mov_b64 exec, -1
PTend_54:
    v_lshrrev_b32 v3, 3, v1
    v_mul_u32_u24 v32, 3584, v3
    v_and_b32 v3, 7, v1
    v_min_u32 v3, 6, v3
    v_lshl_add_u32 v32, v3, 7, v32
    s_and_b32 s55, s44, 1
    s_lshr_b32 s56, s44, 1
    v_and_b32 v3, 15, v1
    v_lshrrev_b32 v4, 4, v1
    v_lshrrev_b32 v5, 1, v3
    v_xor_b32 v5, v5, v4
    v_lshlrev_b32 v5, 4, v5
    v_lshl_add_u32 v5, v3, 7, v5
    s_lshl_b32 s3, s56, 12
    v_add_u32 v5, s3, v5
    v_xor_b32 v6, 64, v5
    v_add_u32 v8, 126976, v5
    v_add_u32 v9, 126976, v6
    v_add_u32 v10, 57344, v5
    v_add_u32 v11, 57344, v6
    v_add_u32 v12, 92160, v5
    v_add_u32 v13, 92160, v6
    v_and_b32 v3, 3, v1
    v_lshlrev_b32 v3, 3, v3
    s_mul_i32 s3, s55, 56
    v_add_u32 v3, s3, v3
    v_bfe_u32 v5, v1, 2, 2
    v_and_b32 v6, 2, v5
    v_lshlrev_b32 v5, 7, v5
    v_lshl_add_u32 v5, v4, 10, v5
    v_and_b32 v4, 1, v4
    v_lshl_or_b32 v6, v4, 2, v6
    v_lshlrev_b32 v6, 4, v6
    v_xor_b32 v4, v3, v6
    v_add_u32 v4, v4, v5
    v_add_u32 v3, 32, v3
    v_xor_b32 v3, v3, v6
    v_add_u32 v3, v3, v5
    v_add_u32 v14, 137216, v4
    v_add_u32 v15, 137216, v3
    v_add_u32 v16, 67584, v4
    v_add_u32 v17, 67584, v3
    v_add_u32 v18, 102400, v4
    v_add_u32 v19, 102400, v3
    v_mov_b32 v20, 0x3f803f80
    v_mov_b32 v21, 0x3f803f80
    v_mov_b32 v22, 0x3f803f80
    v_mov_b32 v23, 0x3f803f80
    v_and_b32 v3, 15, v1
    v_lshrrev_b32 v4, 4, v1
    v_and_b32 v6, 1, v3
    v_cmp_eq_u32 s[60:61], 1, v6
    v_lshl_add_u32 v5, v4, 2, v6
    v_cmp_le_u32 s[64:65], v5, v3
    v_add_u32 v5, 2, v5
    v_cmp_le_u32 s[66:67], v5, v3
    v_and_b32 v6, 2, v3
    v_cmp_eq_u32 s[62:63], 2, v6
    v_lshrrev_b32 v6, 2, v3
    v_cmp_eq_u32 s[68:69], v6, v4
    v_mov_b32 v6, 0xffff
    v_mov_b32 v5, 0xffff0000
    v_cndmask_b32 v6, v6, v5, s[60:61]
    v_cndmask_b32 v33, v6, 0, s[64:65]
    v_cndmask_b32 v34, v6, 0, s[66:67]
    v_cndmask_b32 v35, 0, v6, s[64:65]
    v_cndmask_b32 v36, 0, v6, s[66:67]
    v_cmp_ne_u32 vcc, 3, v4
    s_lshl_b32 s3, s44, 9
    s_add_u32 s3, s3, 161792
    v_cndmask_b32 v37, 0, -1, vcc
    v_lshl_add_u32 v38, v3, 2, s3
    v_lshl_add_u32 v39, v4, 4, s3
    s_or_b32 s3, s48, s56
    s_cmp_eq_u32 s3, 0
    s_cselect_b32 s57, 0xf149f2ca, 0
    v_and_b32 v6, 1, v3
    v_lshl_add_u32 v6, v6, 2, v39
    v_add_u32 v5, 128, v6
    v_cndmask_b32 v40, v6, v5, s[64:65]
    v_cndmask_b32 v41, v6, v5, s[66:67]
    v_mov_b32 v6, s57
    v_cndmask_b32 v42, v6, 0, s[64:65]
    v_cndmask_b32 v43, v6, 0, s[66:67]
    s_lshr_b32 s3, s48, 5
    s_add_u32 s3, s3, s56
    s_lshl_b32 s4, s49, 1
    s_add_u32 s4, s4, s55
    s_lshl_b32 s58, s3, 15
    s_lshl_b32 s59, s4, 10
    s_add_u32 s58, s58, s59
    s_add_u32 s58, s58, 0
    s_add_u32 s59, s58, 16384
    s_lshr_b32 s57, s48, 3
    s_add_u32 s57, s57, s49
    s_lshl_b32 s57, s57, 7
    s_add_u32 s57, s57, 12582912
    s_cmp_lg_u32 s44, 0
    s_cbranch_scc1 WPG0
    s_call_b64 s[6:7], STUB_x1
    s_call_b64 s[6:7], STUB_x4
WPG0:
    s_cmp_lg_u32 s44, 1
    s_cbranch_scc1 WPG1
    s_call_b64 s[6:7], STUB_y1
    s_call_b64 s[6:7], STUB_x3
WPG1:
    s_cmp_lg_u32 s44, 2
    s_cbranch_scc1 WPG2
    s_call_b64 s[6:7], STUB_x5
    s_call_b64 s[6:7], STUB_y3
    s_call_b64 s[6:7], STUB_y4
WPG2:
    s_cmp_lg_u32 s44, 3
    s_cbranch_scc1 WPG3
    s_call_b64 s[6:7], STUB_y2
    s_call_b64 s[6:7], STUB_xm
WPG3:
    s_barrier
    ds_read_b128 v[192:195], v8 offset:0
    ds_read_b128 v[196:199], v8 offset:2048
    ds_read_b128 v[200:203], v8 offset:4096
    ds_read_b64_tr_b16 v[212:213], v14 offset:8192
    ds_read_b64_tr_b16 v[214:215], v14 offset:8704
    ds_read_b64_tr_b16 v[216:217], v15 offset:8192
    ds_read_b64_tr_b16 v[218:219], v15 offset:8704
    ds_read_b64_tr_b16 v[204:205], v14 offset:0
    ds_read_b64_tr_b16 v[206:207], v14 offset:512
    ds_read_b64_tr_b16 v[208:209], v15 offset:0
    ds_read_b64_tr_b16 v[210:211], v15 offset:512
    ds_read_b64_tr_b16 v[220:221], v14 offset:16384
    ds_read_b64_tr_b16 v[222:223], v14 offset:16896
    ds_read_b64_tr_b16 v[224:225], v15 offset:16384
    ds_read_b64_tr_b16 v[226:227], v15 offset:16896
    s_add_u32 s3, s49, 1
    s_and_b32 s3, s3, 7
    s_cmp_ge_u32 s3, 2
    s_cbranch_scc1 WUend_58
    s_bfe_u32 s4, s48, 0x20008
    s_lshl_b32 s4, s4, 1
    s_add_u32 s4, s4, s3
    s_lshl_b32 s4, s4, 2
    s_add_u32 s4, s4, s44
    s_add_u32 s4, s4, 0
    s_mul_i32 s3, s4, 28672
    s_mul_i32 s4, s52, 896
    s_add_u32 s3, s3, s4
    s_bitcmp1_b32 s45, 2
    s_cbranch_scc0 WU_59
    s_waitcnt lgkmcnt(0)
    buffer_load_dword v24, v32, s[24:27], s3 offen
    s_branch WUend_58
WU_59:
    s_waitcnt lgkmcnt(0)
    buffer_load_dword v24, v32, s[20:23], s3 offen
WUend_58:
    s_waitcnt lgkmcnt(0)
    v_mfma_f32_16x16x32_bf16 v[132:135], v[20:23], v[192:195], 0
    v_mfma_f32_16x16x32_bf16 v[144:147], v[192:195], v[192:195], 0
    v_mfma_f32_16x16x32_bf16 v[136:139], v[20:23], v[196:199], 0
    v_mfma_f32_16x16x32_bf16 v[148:151], v[196:199], v[196:199], 0
    v_mfma_f32_16x16x32_bf16 v[140:143], v[20:23], v[200:203], 0
    ds_read_b128 v[156:159], v9 offset:0
    v_mfma_f32_16x16x32_bf16 v[152:155], v[200:203], v[200:203], 0
    ds_read_b128 v[160:163], v9 offset:2048
    v_mfma_f32_16x16x32_bf16 v[60:63], v[212:215], v[192:195], 0
    ds_read_b128 v[164:167], v9 offset:4096
    v_mfma_f32_16x16x32_bf16 v[68:71], v[212:215], v[196:199], 0
    ds_read_b64_tr_b16 v[176:177], v14 offset:12288
    v_mfma_f32_16x16x32_bf16 v[76:79], v[212:215], v[200:203], 0
    ds_read_b64_tr_b16 v[178:179], v14 offset:12800
    v_mfma_f32_16x16x32_bf16 v[116:119], v[212:215], v[20:23], 0
    ds_read_b64_tr_b16 v[180:181], v15 offset:12288
    v_mfma_f32_16x16x32_bf16 v[64:67], v[216:219], v[192:195], 0
    ds_read_b64_tr_b16 v[182:183], v15 offset:12800
    v_mfma_f32_16x16x32_bf16 v[72:75], v[216:219], v[196:199], 0
    ds_read_b64_tr_b16 v[168:169], v14 offset:4096
    v_mfma_f32_16x16x32_bf16 v[80:83], v[216:219], v[200:203], 0
    ds_read_b64_tr_b16 v[170:171], v14 offset:4608
    v_mfma_f32_16x16x32_bf16 v[120:123], v[216:219], v[20:23], 0
    ds_read_b64_tr_b16 v[172:173], v15 offset:4096
    v_mfma_f32_16x16x32_bf16 v[44:47], v[204:207], v[196:199], 0
    ds_read_b64_tr_b16 v[174:175], v15 offset:4608
    v_mfma_f32_16x16x32_bf16 v[52:55], v[204:207], v[200:203], 0
    ds_read_b64_tr_b16 v[184:185], v14 offset:20480
    v_mfma_f32_16x16x32_bf16 v[108:111], v[204:207], v[20:23], 0
    ds_read_b64_tr_b16 v[186:187], v14 offset:20992
    v_mfma_f32_16x16x32_bf16 v[48:51], v[208:211], v[196:199], 0
    ds_read_b64_tr_b16 v[188:189], v15 offset:20480
    v_mfma_f32_16x16x32_bf16 v[56:59], v[208:211], v[200:203], 0
    ds_read_b64_tr_b16 v[190:191], v15 offset:20992
    v_mfma_f32_16x16x32_bf16 v[112:115], v[208:211], v[20:23], 0
    v_mfma_f32_16x16x32_bf16 v[84:87], v[192:195], v[220:223], 0
    v_mfma_f32_16x16x32_bf16 v[92:95], v[196:199], v[220:223], 0
    v_mfma_f32_16x16x32_bf16 v[100:103], v[200:203], v[220:223], 0
    v_mfma_f32_16x16x32_bf16 v[124:127], v[20:23], v[220:223], 0
    v_mfma_f32_16x16x32_bf16 v[88:91], v[192:195], v[224:227], 0
    v_mfma_f32_16x16x32_bf16 v[96:99], v[196:199], v[224:227], 0
    v_mfma_f32_16x16x32_bf16 v[104:107], v[200:203], v[224:227], 0
    v_mfma_f32_16x16x32_bf16 v[128:131], v[20:23], v[224:227], 0
    s_waitcnt lgkmcnt(14)
    v_mfma_f32_16x16x32_bf16 v[132:135], v[20:23], v[156:159], v[132:135]
    v_mfma_f32_16x16x32_bf16 v[144:147], v[156:159], v[156:159], v[144:147]
    s_waitcnt lgkmcnt(13)
    v_mfma_f32_16x16x32_bf16 v[136:139], v[20:23], v[160:163], v[136:139]
    v_mfma_f32_16x16x32_bf16 v[148:151], v[160:163], v[160:163], v[148:151]
    s_waitcnt lgkmcnt(12)
    v_mfma_f32_16x16x32_bf16 v[140:143], v[20:23], v[164:167], v[140:143]
    v_mfma_f32_16x16x32_bf16 v[152:155], v[164:167], v[164:167], v[152:155]
    s_waitcnt lgkmcnt(10)
    v_mfma_f32_16x16x32_bf16 v[60:63], v[176:179], v[156:159], v[60:63]
    v_mfma_f32_16x16x32_bf16 v[68:71], v[176:179], v[160:163], v[68:71]
    v_mfma_f32_16x16x32_bf16 v[76:79], v[176:179], v[164:167], v[76:79]
    v_mfma_f32_16x16x32_bf16 v[116:119], v[176:179], v[20:23], v[116:119]
    s_waitcnt lgkmcnt(8)
    v_mfma_f32_16x16x32_bf16 v[64:67], v[180:183], v[156:159], v[64:67]
    v_mfma_f32_16x16x32_bf16 v[72:75], v[180:183], v[160:163], v[72:75]
    v_mfma_f32_16x16x32_bf16 v[80:83], v[180:183], v[164:167], v[80:83]
    v_mfma_f32_16x16x32_bf16 v[120:123], v[180:183], v[20:23], v[120:123]
    s_waitcnt lgkmcnt(6)
    v_mfma_f32_16x16x32_bf16 v[44:47], v[168:171], v[160:163], v[44:47]
    v_mfma_f32_16x16x32_bf16 v[52:55], v[168:171], v[164:167], v[52:55]
    v_mfma_f32_16x16x32_bf16 v[108:111], v[168:171], v[20:23], v[108:111]
    s_waitcnt lgkmcnt(4)
    v_mfma_f32_16x16x32_bf16 v[48:51], v[172:175], v[160:163], v[48:51]
    s_waitcnt lgkmcnt(0)
    s_barrier
    v_mfma_f32_16x16x32_bf16 v[56:59], v[172:175], v[164:167], v[56:59]
    ds_read_b128 v[192:195], v10 offset:0
    ds_read_b128 v[196:199], v10 offset:2048
    v_mfma_f32_16x16x32_bf16 v[112:115], v[172:175], v[20:23], v[112:115]
    ds_read_b128 v[200:203], v10 offset:4096
    ds_read_b64_tr_b16 v[212:213], v16 offset:8192
    v_mfma_f32_16x16x32_bf16 v[84:87], v[156:159], v[184:187], v[84:87]
    ds_read_b64_tr_b16 v[214:215], v16 offset:8704
    ds_read_b64_tr_b16 v[216:217], v17 offset:8192
    v_mfma_f32_16x16x32_bf16 v[92:95], v[160:163], v[184:187], v[92:95]
    ds_read_b64_tr_b16 v[218:219], v17 offset:8704
    ds_read_b64_tr_b16 v[204:205], v16 offset:0
    v_mfma_f32_16x16x32_bf16 v[100:103], v[164:167], v[184:187], v[100:103]
    ds_read_b64_tr_b16 v[206:207], v16 offset:512
    ds_read_b64_tr_b16 v[208:209], v17 offset:0
    v_mfma_f32_16x16x32_bf16 v[124:127], v[20:23], v[184:187], v[124:127]
    ds_read_b64_tr_b16 v[210:211], v17 offset:512
    ds_read_b64_tr_b16 v[220:221], v16 offset:16384
    v_mfma_f32_16x16x32_bf16 v[88:91], v[156:159], v[188:191], v[88:91]
    ds_read_b64_tr_b16 v[222:223], v16 offset:16896
    ds_read_b64_tr_b16 v[224:225], v17 offset:16384
    v_mfma_f32_16x16x32_bf16 v[96:99], v[160:163], v[188:191], v[96:99]
    ds_read_b64_tr_b16 v[226:227], v17 offset:16896
    v_mfma_f32_16x16x32_bf16 v[104:107], v[164:167], v[188:191], v[104:107]
    v_mfma_f32_16x16x32_bf16 v[128:131], v[20:23], v[188:191], v[128:131]
    s_waitcnt lgkmcnt(14)
    v_mfma_f32_16x16x32_bf16 v[132:135], v[20:23], v[192:195], v[132:135]
    v_mfma_f32_16x16x32_bf16 v[144:147], v[192:195], v[192:195], v[144:147]
    s_waitcnt lgkmcnt(13)
    v_mfma_f32_16x16x32_bf16 v[136:139], v[20:23], v[196:199], v[136:139]
    v_mfma_f32_16x16x32_bf16 v[148:151], v[196:199], v[196:199], v[148:151]
    s_waitcnt lgkmcnt(12)
    v_mfma_f32_16x16x32_bf16 v[140:143], v[20:23], v[200:203], v[140:143]
    ds_read_b128 v[156:159], v11 offset:0
    v_mfma_f32_16x16x32_bf16 v[152:155], v[200:203], v[200:203], v[152:155]
    ds_read_b128 v[160:163], v11 offset:2048
    s_waitcnt lgkmcnt(12)
    v_mfma_f32_16x16x32_bf16 v[60:63], v[212:215], v[192:195], v[60:63]
    ds_read_b128 v[164:167], v11 offset:4096
    v_mfma_f32_16x16x32_bf16 v[68:71], v[212:215], v[196:199], v[68:71]
    ds_read_b64_tr_b16 v[176:177], v16 offset:12288
    v_mfma_f32_16x16x32_bf16 v[76:79], v[212:215], v[200:203], v[76:79]
    ds_read_b64_tr_b16 v[178:179], v16 offset:12800
    v_mfma_f32_16x16x32_bf16 v[116:119], v[212:215], v[20:23], v[116:119]
    ds_read_b64_tr_b16 v[180:181], v17 offset:12288
    s_waitcnt lgkmcnt(14)
    v_mfma_f32_16x16x32_bf16 v[64:67], v[216:219], v[192:195], v[64:67]
    ds_read_b64_tr_b16 v[182:183], v17 offset:12800
    v_mfma_f32_16x16x32_bf16 v[72:75], v[216:219], v[196:199], v[72:75]
    ds_read_b64_tr_b16 v[168:169], v16 offset:4096
    v_mfma_f32_16x16x32_bf16 v[80:83], v[216:219], v[200:203], v[80:83]
    ds_read_b64_tr_b16 v[170:171], v16 offset:4608
    v_mfma_f32_16x16x32_bf16 v[120:123], v[216:219], v[20:23], v[120:123]
    ds_read_b64_tr_b16 v[172:173], v17 offset:4096
    s_waitcnt lgkmcnt(15)
    v_mfma_f32_16x16x32_bf16 v[44:47], v[204:207], v[196:199], v[44:47]
    ds_read_b64_tr_b16 v[174:175], v17 offset:4608
    v_mfma_f32_16x16x32_bf16 v[52:55], v[204:207], v[200:203], v[52:55]
    ds_read_b64_tr_b16 v[184:185], v16 offset:20480
    v_mfma_f32_16x16x32_bf16 v[108:111], v[204:207], v[20:23], v[108:111]
    ds_read_b64_tr_b16 v[186:187], v16 offset:20992
    s_waitcnt lgkmcnt(15)
    v_mfma_f32_16x16x32_bf16 v[48:51], v[208:211], v[196:199], v[48:51]
    ds_read_b64_tr_b16 v[188:189], v17 offset:20480
    v_mfma_f32_16x16x32_bf16 v[56:59], v[208:211], v[200:203], v[56:59]
    ds_read_b64_tr_b16 v[190:191], v17 offset:20992
    v_mfma_f32_16x16x32_bf16 v[112:115], v[208:211], v[20:23], v[112:115]
    v_mfma_f32_16x16x32_bf16 v[84:87], v[192:195], v[220:223], v[84:87]
    v_mfma_f32_16x16x32_bf16 v[92:95], v[196:199], v[220:223], v[92:95]
    v_mfma_f32_16x16x32_bf16 v[100:103], v[200:203], v[220:223], v[100:103]
    v_mfma_f32_16x16x32_bf16 v[124:127], v[20:23], v[220:223], v[124:127]
    s_waitcnt lgkmcnt(15)
    v_mfma_f32_16x16x32_bf16 v[88:91], v[192:195], v[224:227], v[88:91]
    v_mfma_f32_16x16x32_bf16 v[96:99], v[196:199], v[224:227], v[96:99]
    v_mfma_f32_16x16x32_bf16 v[104:107], v[200:203], v[224:227], v[104:107]
    v_mfma_f32_16x16x32_bf16 v[128:131], v[20:23], v[224:227], v[128:131]
    s_waitcnt lgkmcnt(14)
    v_mfma_f32_16x16x32_bf16 v[132:135], v[20:23], v[156:159], v[132:135]
    v_mfma_f32_16x16x32_bf16 v[144:147], v[156:159], v[156:159], v[144:147]
    s_waitcnt lgkmcnt(13)
    v_mfma_f32_16x16x32_bf16 v[136:139], v[20:23], v[160:163], v[136:139]
    v_mfma_f32_16x16x32_bf16 v[148:151], v[160:163], v[160:163], v[148:151]
    s_waitcnt lgkmcnt(12)
    v_mfma_f32_16x16x32_bf16 v[140:143], v[20:23], v[164:167], v[140:143]
    v_mfma_f32_16x16x32_bf16 v[152:155], v[164:167], v[164:167], v[152:155]
    s_waitcnt lgkmcnt(10)
    v_mfma_f32_16x16x32_bf16 v[60:63], v[176:179], v[156:159], v[60:63]
    v_mfma_f32_16x16x32_bf16 v[68:71], v[176:179], v[160:163], v[68:71]
    v_mfma_f32_16x16x32_bf16 v[76:79], v[176:179], v[164:167], v[76:79]
    v_mfma_f32_16x16x32_bf16 v[116:119], v[176:179], v[20:23], v[116:119]
    s_waitcnt lgkmcnt(8)
    v_mfma_f32_16x16x32_bf16 v[64:67], v[180:183], v[156:159], v[64:67]
    v_mfma_f32_16x16x32_bf16 v[72:75], v[180:183], v[160:163], v[72:75]
    v_mfma_f32_16x16x32_bf16 v[80:83], v[180:183], v[164:167], v[80:83]
    v_mfma_f32_16x16x32_bf16 v[120:123], v[180:183], v[20:23], v[120:123]
    s_waitcnt lgkmcnt(6)
    v_mfma_f32_16x16x32_bf16 v[44:47], v[168:171], v[160:163], v[44:47]
    v_mfma_f32_16x16x32_bf16 v[52:55], v[168:171], v[164:167], v[52:55]
    v_mfma_f32_16x16x32_bf16 v[108:111], v[168:171], v[20:23], v[108:111]
    s_waitcnt lgkmcnt(4)
    v_mfma_f32_16x16x32_bf16 v[48:51], v[172:175], v[160:163], v[48:51]
    s_branch PG_60
.p2align 12
STUB_x1:
    s_setpc_b64 s[6:7]
    s_nop 0
PG_60:
    s_waitcnt lgkmcnt(0)
    s_barrier
    s_add_u32 s3, s49, 1
    s_and_b32 s3, s3, 7
    s_cmp_ge_u32 s3, 2
    s_cbranch_scc1 WUend_61
    s_bfe_u32 s4, s48, 0x20008
    s_lshl_b32 s4, s4, 1
    s_add_u32 s4, s4, s3
    s_lshl_b32 s4, s4, 2
    s_add_u32 s4, s4, s44
    s_add_u32 s4, s4, 32
    s_mul_i32 s3, s4, 28672
    s_mul_i32 s4, s52, 896
    s_add_u32 s3, s3, s4
    s_bitcmp1_b32 s45, 2
    s_cbranch_scc0 WU_62
    buffer_load_dword v25, v32, s[24:27], s3 offen
    s_branch WUend_61
WU_62:
    buffer_load_dword v25, v32, s[20:23], s3 offen
WUend_61:
    s_add_u32 s3, s49, 1
    s_and_b32 s3, s3, 7
    s_cmp_ge_u32 s3, 2
    s_cbranch_scc1 WUend_63
    s_bfe_u32 s4, s48, 0x20008
    s_lshl_b32 s4, s4, 1
    s_add_u32 s4, s4, s3
    s_lshl_b32 s4, s4, 2
    s_add_u32 s4, s4, s44
    s_sub_u32 s4, s4, 24
    s_cmp_ge_u32 s4, 7
    s_cbranch_scc1 WUend_63
    s_mul_i32 s3, s45, 7
    s_add_u32 s3, s3, s4
    s_lshl_b32 s3, s3, 13
    buffer_load_dword v28, v7, s[16:19], s3 offen
WUend_63:
    v_mfma_f32_16x16x32_bf16 v[56:59], v[172:175], v[164:167], v[56:59]
    ds_read_b128 v[192:195], v12 offset:0
    ds_read_b128 v[196:199], v12 offset:2048
    v_mfma_f32_16x16x32_bf16 v[112:115], v[172:175], v[20:23], v[112:115]
    ds_read_b128 v[200:203], v12 offset:4096
    ds_read_b64_tr_b16 v[212:213], v18 offset:8192
    v_mfma_f32_16x16x32_bf16 v[84:87], v[156:159], v[184:187], v[84:87]
    ds_read_b64_tr_b16 v[214:215], v18 offset:8704
    ds_read_b64_tr_b16 v[216:217], v19 offset:8192
    v_mfma_f32_16x16x32_bf16 v[92:95], v[160:163], v[184:187], v[92:95]
    ds_read_b64_tr_b16 v[218:219], v19 offset:8704
    ds_read_b64_tr_b16 v[204:205], v18 offset:0
    v_mfma_f32_16x16x32_bf16 v[100:103], v[164:167], v[184:187], v[100:103]
    ds_read_b64_tr_b16 v[206:207], v18 offset:512
    ds_read_b64_tr_b16 v[208:209], v19 offset:0
    v_mfma_f32_16x16x32_bf16 v[124:127], v[20:23], v[184:187], v[124:127]
    ds_read_b64_tr_b16 v[210:211], v19 offset:512
    ds_read_b64_tr_b16 v[220:221], v18 offset:16384
    v_mfma_f32_16x16x32_bf16 v[88:91], v[156:159], v[188:191], v[88:91]
    ds_read_b64_tr_b16 v[222:223], v18 offset:16896
    ds_read_b64_tr_b16 v[224:225], v19 offset:16384
    v_mfma_f32_16x16x32_bf16 v[96:99], v[160:163], v[188:191], v[96:99]
    ds_read_b64_tr_b16 v[226:227], v19 offset:16896
    v_mfma_f32_16x16x32_bf16 v[104:107], v[164:167], v[188:191], v[104:107]
    v_mfma_f32_16x16x32_bf16 v[128:131], v[20:23], v[188:191], v[128:131]
    s_waitcnt lgkmcnt(14)
    v_mfma_f32_16x16x32_bf16 v[132:135], v[20:23], v[192:195], v[132:135]
    v_mfma_f32_16x16x32_bf16 v[144:147], v[192:195], v[192:195], v[144:147]
    s_waitcnt lgkmcnt(13)
    v_mfma_f32_16x16x32_bf16 v[136:139], v[20:23], v[196:199], v[136:139]
    v_mfma_f32_16x16x32_bf16 v[148:151], v[196:199], v[196:199], v[148:151]
    s_waitcnt lgkmcnt(12)
    v_mfma_f32_16x16x32_bf16 v[140:143], v[20:23], v[200:203], v[140:143]
    ds_read_b128 v[156:159], v13 offset:0
    v_mfma_f32_16x16x32_bf16 v[152:155], v[200:203], v[200:203], v[152:155]
    ds_read_b128 v[160:163], v13 offset:2048
    s_waitcnt lgkmcnt(12)
    v_mfma_f32_16x16x32_bf16 v[60:63], v[212:215], v[192:195], v[60:63]
    ds_read_b128 v[164:167], v13 offset:4096
    v_mfma_f32_16x16x32_bf16 v[68:71], v[212:215], v[196:199], v[68:71]
    ds_read_b64_tr_b16 v[176:177], v18 offset:12288
    v_mfma_f32_16x16x32_bf16 v[76:79], v[212:215], v[200:203], v[76:79]
    ds_read_b64_tr_b16 v[178:179], v18 offset:12800
    v_mfma_f32_16x16x32_bf16 v[116:119], v[212:215], v[20:23], v[116:119]
    ds_read_b64_tr_b16 v[180:181], v19 offset:12288
    s_waitcnt lgkmcnt(14)
    v_mfma_f32_16x16x32_bf16 v[64:67], v[216:219], v[192:195], v[64:67]
    ds_read_b64_tr_b16 v[182:183], v19 offset:12800
    v_mfma_f32_16x16x32_bf16 v[72:75], v[216:219], v[196:199], v[72:75]
    ds_read_b64_tr_b16 v[168:169], v18 offset:4096
    v_mfma_f32_16x16x32_bf16 v[80:83], v[216:219], v[200:203], v[80:83]
    ds_read_b64_tr_b16 v[170:171], v18 offset:4608
    v_mfma_f32_16x16x32_bf16 v[120:123], v[216:219], v[20:23], v[120:123]
    ds_read_b64_tr_b16 v[172:173], v19 offset:4096
    s_waitcnt lgkmcnt(15)
    v_mfma_f32_16x16x32_bf16 v[44:47], v[204:207], v[196:199], v[44:47]
    ds_read_b64_tr_b16 v[174:175], v19 offset:4608
    v_mfma_f32_16x16x32_bf16 v[52:55], v[204:207], v[200:203], v[52:55]
    ds_read_b64_tr_b16 v[184:185], v18 offset:20480
    v_mfma_f32_16x16x32_bf16 v[108:111], v[204:207], v[20:23], v[108:111]
    ds_read_b64_tr_b16 v[186:187], v18 offset:20992
    s_waitcnt lgkmcnt(15)
    v_mfma_f32_16x16x32_bf16 v[48:51], v[208:211], v[196:199], v[48:51]
    ds_read_b64_tr_b16 v[188:189], v19 offset:20480
    v_mfma_f32_16x16x32_bf16 v[56:59], v[208:211], v[200:203], v[56:59]
    ds_read_b64_tr_b16 v[190:191], v19 offset:20992
    v_mfma_f32_16x16x32_bf16 v[112:115], v[208:211], v[20:23], v[112:115]
    v_mfma_f32_16x16x32_bf16 v[84:87], v[192:195], v[220:223], v[84:87]
    v_mfma_f32_16x16x32_bf16 v[92:95], v[196:199], v[220:223], v[92:95]
    v_mfma_f32_16x16x32_bf16 v[100:103], v[200:203], v[220:223], v[100:103]
    v_mfma_f32_16x16x32_bf16 v[124:127], v[20:23], v[220:223], v[124:127]
    s_waitcnt lgkmcnt(15)
    v_mfma_f32_16x16x32_bf16 v[88:91], v[192:195], v[224:227], v[88:91]
    v_mfma_f32_16x16x32_bf16 v[96:99], v[196:199], v[224:227], v[96:99]
    v_mfma_f32_16x16x32_bf16 v[104:107], v[200:203], v[224:227], v[104:107]
    v_mfma_f32_16x16x32_bf16 v[128:131], v[20:23], v[224:227], v[128:131]
    s_waitcnt lgkmcnt(14)
    v_mfma_f32_16x16x32_bf16 v[132:135], v[20:23], v[156:159], v[132:135]
    v_mfma_f32_16x16x32_bf16 v[144:147], v[156:159], v[156:159], v[144:147]
    s_waitcnt lgkmcnt(13)
    v_mfma_f32_16x16x32_bf16 v[136:139], v[20:23], v[160:163], v[136:139]
    v_mfma_f32_16x16x32_bf16 v[148:151], v[160:163], v[160:163], v[148:151]
    s_waitcnt lgkmcnt(12)
    v_mfma_f32_16x16x32_bf16 v[140:143], v[20:23], v[164:167], v[140:143]
    v_mfma_f32_16x16x32_bf16 v[152:155], v[164:167], v[164:167], v[152:155]
    s_waitcnt lgkmcnt(10)
    v_mfma_f32_16x16x32_bf16 v[60:63], v[176:179], v[156:159], v[60:63]
    v_mfma_f32_16x16x32_bf16 v[68:71], v[176:179], v[160:163], v[68:71]
    v_mfma_f32_16x16x32_bf16 v[76:79], v[176:179], v[164:167], v[76:79]
    v_mfma_f32_16x16x32_bf16 v[116:119], v[176:179], v[20:23], v[116:119]
    s_waitcnt lgkmcnt(8)
    v_mfma_f32_16x16x32_bf16 v[64:67], v[180:183], v[156:159], v[64:67]
    v_mfma_f32_16x16x32_bf16 v[72:75], v[180:183], v[160:163], v[72:75]
    v_mfma_f32_16x16x32_bf16 v[80:83], v[180:183], v[164:167], v[80:83]
    v_mfma_f32_16x16x32_bf16 v[120:123], v[180:183], v[20:23], v[120:123]
    s_waitcnt lgkmcnt(6)
    v_mfma_f32_16x16x32_bf16 v[44:47], v[168:171], v[160:163], v[44:47]
    v_mfma_f32_16x16x32_bf16 v[52:55], v[168:171], v[164:167], v[52:55]
    v_mfma_f32_16x16x32_bf16 v[108:111], v[168:171], v[20:23], v[108:111]
    s_waitcnt lgkmcnt(4)
    v_mfma_f32_16x16x32_bf16 v[48:51], v[172:175], v[160:163], v[48:51]
    s_waitcnt lgkmcnt(0)
    s_barrier
    v_mfma_f32_16x16x32_bf16 v[56:59], v[172:175], v[164:167], v[56:59]
    ds_read_b128 v[192:195], v8 offset:0
    ds_read_b128 v[196:199], v8 offset:2048
    v_mfma_f32_16x16x32_bf16 v[112:115], v[172:175], v[20:23], v[112:115]
    ds_read_b128 v[200:203], v8 offset:4096
    ds_read_b64_tr_b16 v[212:213], v14 offset:8192
    v_mfma_f32_16x16x32_bf16 v[84:87], v[156:159], v[184:187], v[84:87]
    ds_read_b64_tr_b16 v[214:215], v14 offset:8704
    ds_read_b64_tr_b16 v[216:217], v15 offset:8192
    v_mfma_f32_16x16x32_bf16 v[92:95], v[160:163], v[184:187], v[92:95]
    ds_read_b64_tr_b16 v[218:219], v15 offset:8704
    ds_read_b64_tr_b16 v[204:205], v14 offset:0
    v_mfma_f32_16x16x32_bf16 v[100:103], v[164:167], v[184:187], v[100:103]
    ds_read_b64_tr_b16 v[206:207], v14 offset:512
    ds_read_b64_tr_b16 v[208:209], v15 offset:0
    v_mfma_f32_16x16x32_bf16 v[124:127], v[20:23], v[184:187], v[124:127]
    ds_read_b64_tr_b16 v[210:211], v15 offset:512
    ds_read_b64_tr_b16 v[220:221], v14 offset:16384
    v_mfma_f32_16x16x32_bf16 v[88:91], v[156:159], v[188:191], v[88:91]
    ds_read_b64_tr_b16 v[222:223], v14 offset:16896
    ds_read_b64_tr_b16 v[224:225], v15 offset:16384
    v_mfma_f32_16x16x32_bf16 v[96:99], v[160:163], v[188:191], v[96:99]
    ds_read_b64_tr_b16 v[226:227], v15 offset:16896
    v_mfma_f32_16x16x32_bf16 v[104:107], v[164:167], v[188:191], v[104:107]
    v_mfma_f32_16x16x32_bf16 v[128:131], v[20:23], v[188:191], v[128:131]
    s_waitcnt lgkmcnt(14)
    v_mfma_f32_16x16x32_bf16 v[132:135], v[20:23], v[192:195], v[132:135]
    v_mfma_f32_16x16x32_bf16 v[144:147], v[192:195], v[192:195], v[144:147]
    s_waitcnt lgkmcnt(13)
    v_mfma_f32_16x16x32_bf16 v[136:139], v[20:23], v[196:199], v[136:139]
    v_mfma_f32_16x16x32_bf16 v[148:151], v[196:199], v[196:199], v[148:151]
    s_waitcnt lgkmcnt(12)
    v_mfma_f32_16x16x32_bf16 v[140:143], v[20:23], v[200:203], v[140:143]
    ds_read_b128 v[156:159], v9 offset:0
    v_mfma_f32_16x16x32_bf16 v[152:155], v[200:203], v[200:203], v[152:155]
    ds_read_b128 v[160:163], v9 offset:2048
    s_waitcnt lgkmcnt(12)
    v_mfma_f32_16x16x32_bf16 v[60:63], v[212:215], v[192:195], v[60:63]
    ds_read_b128 v[164:167], v9 offset:4096
    v_mfma_f32_16x16x32_bf16 v[68:71], v[212:215], v[196:199], v[68:71]
    ds_read_b64_tr_b16 v[176:177], v14 offset:12288
    v_mfma_f32_16x16x32_bf16 v[76:79], v[212:215], v[200:203], v[76:79]
    ds_read_b64_tr_b16 v[178:179], v14 offset:12800
    v_mfma_f32_16x16x32_bf16 v[116:119], v[212:215], v[20:23], v[116:119]
    ds_read_b64_tr_b16 v[180:181], v15 offset:12288
    s_waitcnt lgkmcnt(14)
    v_mfma_f32_16x16x32_bf16 v[64:67], v[216:219], v[192:195], v[64:67]
    ds_read_b64_tr_b16 v[182:183], v15 offset:12800
    v_mfma_f32_16x16x32_bf16 v[72:75], v[216:219], v[196:199], v[72:75]
    ds_read_b64_tr_b16 v[168:169], v14 offset:4096
    v_mfma_f32_16x16x32_bf16 v[80:83], v[216:219], v[200:203], v[80:83]
    ds_read_b64_tr_b16 v[170:171], v14 offset:4608
    v_mfma_f32_16x16x32_bf16 v[120:123], v[216:219], v[20:23], v[120:123]
    ds_read_b64_tr_b16 v[172:173], v15 offset:4096
    s_waitcnt lgkmcnt(15)
    v_mfma_f32_16x16x32_bf16 v[44:47], v[204:207], v[196:199], v[44:47]
    ds_read_b64_tr_b16 v[174:175], v15 offset:4608
    v_mfma_f32_16x16x32_bf16 v[52:55], v[204:207], v[200:203], v[52:55]
    ds_read_b64_tr_b16 v[184:185], v14 offset:20480
    v_mfma_f32_16x16x32_bf16 v[108:111], v[204:207], v[20:23], v[108:111]
    ds_read_b64_tr_b16 v[186:187], v14 offset:20992
    s_waitcnt lgkmcnt(15)
    v_mfma_f32_16x16x32_bf16 v[48:51], v[208:211], v[196:199], v[48:51]
    ds_read_b64_tr_b16 v[188:189], v15 offset:20480
    v_mfma_f32_16x16x32_bf16 v[56:59], v[208:211], v[200:203], v[56:59]
    ds_read_b64_tr_b16 v[190:191], v15 offset:20992
    v_mfma_f32_16x16x32_bf16 v[112:115], v[208:211], v[20:23], v[112:115]
    v_mfma_f32_16x16x32_bf16 v[84:87], v[192:195], v[220:223], v[84:87]
    v_mfma_f32_16x16x32_bf16 v[92:95], v[196:199], v[220:223], v[92:95]
    v_mfma_f32_16x16x32_bf16 v[100:103], v[200:203], v[220:223], v[100:103]
    v_mfma_f32_16x16x32_bf16 v[124:127], v[20:23], v[220:223], v[124:127]
    s_waitcnt lgkmcnt(15)
    v_mfma_f32_16x16x32_bf16 v[88:91], v[192:195], v[224:227], v[88:91]
    v_mfma_f32_16x16x32_bf16 v[96:99], v[196:199], v[224:227], v[96:99]
    v_mfma_f32_16x16x32_bf16 v[104:107], v[200:203], v[224:227], v[104:107]
    v_mfma_f32_16x16x32_bf16 v[128:131], v[20:23], v[224:227], v[128:131]
    s_waitcnt lgkmcnt(14)
    v_mfma_f32_16x16x32_bf16 v[132:135], v[20:23], v[156:159], v[132:135]
    v_mfma_f32_16x16x32_bf16 v[144:147], v[156:159], v[156:159], v[144:147]
    s_waitcnt lgkmcnt(13)
    v_mfma_f32_16x16x32_bf16 v[136:139], v[20:23], v[160:163], v[136:139]
    v_mfma_f32_16x16x32_bf16 v[148:151], v[160:163], v[160:163], v[148:151]
    s_waitcnt lgkmcnt(12)
    v_mfma_f32_16x16x32_bf16 v[140:143], v[20:23], v[164:167], v[140:143]
    v_mfma_f32_16x16x32_bf16 v[152:155], v[164:167], v[164:167], v[152:155]
    s_waitcnt lgkmcnt(10)
    v_mfma_f32_16x16x32_bf16 v[60:63], v[176:179], v[156:159], v[60:63]
    v_mfma_f32_16x16x32_bf16 v[68:71], v[176:179], v[160:163], v[68:71]
    v_mfma_f32_16x16x32_bf16 v[76:79], v[176:179], v[164:167], v[76:79]
    v_mfma_f32_16x16x32_bf16 v[116:119], v[176:179], v[20:23], v[116:119]
    s_waitcnt lgkmcnt(8)
    v_mfma_f32_16x16x32_bf16 v[64:67], v[180:183], v[156:159], v[64:67]
    v_mfma_f32_16x16x32_bf16 v[72:75], v[180:183], v[160:163], v[72:75]
    v_mfma_f32_16x16x32_bf16 v[80:83], v[180:183], v[164:167], v[80:83]
    v_mfma_f32_16x16x32_bf16 v[120:123], v[180:183], v[20:23], v[120:123]
    s_waitcnt lgkmcnt(6)
    v_mfma_f32_16x16x32_bf16 v[44:47], v[168:171], v[160:163], v[44:47]
    v_mfma_f32_16x16x32_bf16 v[52:55], v[168:171], v[164:167], v[52:55]
    v_mfma_f32_16x16x32_bf16 v[108:111], v[168:171], v[20:23], v[108:111]
    s_waitcnt lgkmcnt(4)
    v_mfma_f32_16x16x32_bf16 v[48:51], v[172:175], v[160:163], v[48:51]
    s_waitcnt lgkmcnt(0)
    s_barrier
    s_add_u32 s3, s49, 1
    s_and_b32 s3, s3, 7
    s_cmp_ge_u32 s3, 2
    s_cbranch_scc1 WUend_65
    s_bfe_u32 s4, s48, 0x20008
    s_lshl_b32 s4, s4, 1
    s_add_u32 s4, s4, s3
    s_lshl_b32 s4, s4, 2
    s_add_u32 s4, s4, s44
    s_add_u32 s4, s4, 0
    s_mul_i32 s3, s4, 28672
    s_mul_i32 s4, s52, 896
    s_add_u32 s3, s3, s4
    s_bitcmp1_b32 s45, 2
    s_cbranch_scc1 WU_66
    buffer_load_dword v26, v32, s[24:27], s3 offen
    s_branch WUend_65
WU_66:
    buffer_load_dword v26, v32, s[20:23], s3 offen
WUend_65:
    v_mfma_f32_16x16x32_bf16 v[56:59], v[172:175], v[164:167], v[56:59]
    ds_read_b128 v[192:195], v10 offset:0
    ds_read_b128 v[196:199], v10 offset:2048
    v_mfma_f32_16x16x32_bf16 v[112:115], v[172:175], v[20:23], v[112:115]
    ds_read_b128 v[200:203], v10 offset:4096
    ds_read_b64_tr_b16 v[212:213], v16 offset:8192
    v_mfma_f32_16x16x32_bf16 v[84:87], v[156:159], v[184:187], v[84:87]
    ds_read_b64_tr_b16 v[214:215], v16 offset:8704
    ds_read_b64_tr_b16 v[216:217], v17 offset:8192
    v_mfma_f32_16x16x32_bf16 v[92:95], v[160:163], v[184:187], v[92:95]
    ds_read_b64_tr_b16 v[218:219], v17 offset:8704
    ds_read_b64_tr_b16 v[204:205], v16 offset:0
    v_mfma_f32_16x16x32_bf16 v[100:103], v[164:167], v[184:187], v[100:103]
    ds_read_b64_tr_b16 v[206:207], v16 offset:512
    ds_read_b64_tr_b16 v[208:209], v17 offset:0
    v_mfma_f32_16x16x32_bf16 v[124:127], v[20:23], v[184:187], v[124:127]
    ds_read_b64_tr_b16 v[210:211], v17 offset:512
    ds_read_b64_tr_b16 v[220:221], v16 offset:16384
    v_mfma_f32_16x16x32_bf16 v[88:91], v[156:159], v[188:191], v[88:91]
    ds_read_b64_tr_b16 v[222:223], v16 offset:16896
    ds_read_b64_tr_b16 v[224:225], v17 offset:16384
    v_mfma_f32_16x16x32_bf16 v[96:99], v[160:163], v[188:191], v[96:99]
    ds_read_b64_tr_b16 v[226:227], v17 offset:16896
    v_mfma_f32_16x16x32_bf16 v[104:107], v[164:167], v[188:191], v[104:107]
    v_mfma_f32_16x16x32_bf16 v[128:131], v[20:23], v[188:191], v[128:131]
    s_waitcnt lgkmcnt(14)
    v_mfma_f32_16x16x32_bf16 v[132:135], v[20:23], v[192:195], v[132:135]
    v_mfma_f32_16x16x32_bf16 v[144:147], v[192:195], v[192:195], v[144:147]
    s_waitcnt lgkmcnt(13)
    v_mfma_f32_16x16x32_bf16 v[136:139], v[20:23], v[196:199], v[136:139]
    v_mfma_f32_16x16x32_bf16 v[148:151], v[196:199], v[196:199], v[148:151]
    s_waitcnt lgkmcnt(12)
    v_mfma_f32_16x16x32_bf16 v[140:143], v[20:23], v[200:203], v[140:143]
    ds_read_b128 v[156:159], v11 offset:0
    v_mfma_f32_16x16x32_bf16 v[152:155], v[200:203], v[200:203], v[152:155]
    ds_read_b128 v[160:163], v11 offset:2048
    s_waitcnt lgkmcnt(12)
    v_mfma_f32_16x16x32_bf16 v[60:63], v[212:215], v[192:195], v[60:63]
    ds_read_b128 v[164:167], v11 offset:4096
    v_mfma_f32_16x16x32_bf16 v[68:71], v[212:215], v[196:199], v[68:71]
    ds_read_b64_tr_b16 v[176:177], v16 offset:12288
    v_mfma_f32_16x16x32_bf16 v[76:79], v[212:215], v[200:203], v[76:79]
    ds_read_b64_tr_b16 v[178:179], v16 offset:12800
    v_mfma_f32_16x16x32_bf16 v[116:119], v[212:215], v[20:23], v[116:119]
    ds_read_b64_tr_b16 v[180:181], v17 offset:12288
    s_waitcnt lgkmcnt(14)
    v_mfma_f32_16x16x32_bf16 v[64:67], v[216:219], v[192:195], v[64:67]
    ds_read_b64_tr_b16 v[182:183], v17 offset:12800
    v_mfma_f32_16x16x32_bf16 v[72:75], v[216:219], v[196:199], v[72:75]
    ds_read_b64_tr_b16 v[168:169], v16 offset:4096
    v_mfma_f32_16x16x32_bf16 v[80:83], v[216:219], v[200:203], v[80:83]
    ds_read_b64_tr_b16 v[170:171], v16 offset:4608
    v_mfma_f32_16x16x32_bf16 v[120:123], v[216:219], v[20:23], v[120:123]
    ds_read_b64_tr_b16 v[172:173], v17 offset:4096
    s_waitcnt lgkmcnt(15)
    v_mfma_f32_16x16x32_bf16 v[44:47], v[204:207], v[196:199], v[44:47]
    ds_read_b64_tr_b16 v[174:175], v17 offset:4608
    v_mfma_f32_16x16x32_bf16 v[52:55], v[204:207], v[200:203], v[52:55]
    ds_read_b64_tr_b16 v[184:185], v16 offset:20480
    v_mfma_f32_16x16x32_bf16 v[108:111], v[204:207], v[20:23], v[108:111]
    ds_read_b64_tr_b16 v[186:187], v16 offset:20992
    s_waitcnt lgkmcnt(15)
    v_mfma_f32_16x16x32_bf16 v[48:51], v[208:211], v[196:199], v[48:51]
    ds_read_b64_tr_b16 v[188:189], v17 offset:20480
    v_mfma_f32_16x16x32_bf16 v[56:59], v[208:211], v[200:203], v[56:59]
    ds_read_b64_tr_b16 v[190:191], v17 offset:20992
    v_mfma_f32_16x16x32_bf16 v[112:115], v[208:211], v[20:23], v[112:115]
    v_mfma_f32_16x16x32_bf16 v[84:87], v[192:195], v[220:223], v[84:87]
    v_mfma_f32_16x16x32_bf16 v[92:95], v[196:199], v[220:223], v[92:95]
    v_mfma_f32_16x16x32_bf16 v[100:103], v[200:203], v[220:223], v[100:103]
    v_mfma_f32_16x16x32_bf16 v[124:127], v[20:23], v[220:223], v[124:127]
    s_waitcnt lgkmcnt(15)
    v_mfma_f32_16x16x32_bf16 v[88:91], v[192:195], v[224:227], v[88:91]
    v_mfma_f32_16x16x32_bf16 v[96:99], v[196:199], v[224:227], v[96:99]
    v_mfma_f32_16x16x32_bf16 v[104:107], v[200:203], v[224:227], v[104:107]
    v_mfma_f32_16x16x32_bf16 v[128:131], v[20:23], v[224:227], v[128:131]
    s_waitcnt lgkmcnt(14)
    v_mfma_f32_16x16x32_bf16 v[132:135], v[20:23], v[156:159], v[132:135]
    v_mfma_f32_16x16x32_bf16 v[144:147], v[156:159], v[156:159], v[144:147]
    s_waitcnt lgkmcnt(13)
    v_mfma_f32_16x16x32_bf16 v[136:139], v[20:23], v[160:163], v[136:139]
    v_mfma_f32_16x16x32_bf16 v[148:151], v[160:163], v[160:163], v[148:151]
    s_waitcnt lgkmcnt(12)
    v_mfma_f32_16x16x32_bf16 v[140:143], v[20:23], v[164:167], v[140:143]
    v_mfma_f32_16x16x32_bf16 v[152:155], v[164:167], v[164:167], v[152:155]
    s_waitcnt lgkmcnt(10)
    v_mfma_f32_16x16x32_bf16 v[60:63], v[176:179], v[156:159], v[60:63]
    v_mfma_f32_16x16x32_bf16 v[68:71], v[176:179], v[160:163], v[68:71]
    v_mfma_f32_16x16x32_bf16 v[76:79], v[176:179], v[164:167], v[76:79]
    v_mfma_f32_16x16x32_bf16 v[116:119], v[176:179], v[20:23], v[116:119]
    s_waitcnt lgkmcnt(8)
    v_mfma_f32_16x16x32_bf16 v[64:67], v[180:183], v[156:159], v[64:67]
    v_mfma_f32_16x16x32_bf16 v[72:75], v[180:183], v[160:163], v[72:75]
    v_mfma_f32_16x16x32_bf16 v[80:83], v[180:183], v[164:167], v[80:83]
    v_mfma_f32_16x16x32_bf16 v[120:123], v[180:183], v[20:23], v[120:123]
    s_waitcnt lgkmcnt(6)
    v_mfma_f32_16x16x32_bf16 v[44:47], v[168:171], v[160:163], v[44:47]
    v_mfma_f32_16x16x32_bf16 v[52:55], v[168:171], v[164:167], v[52:55]
    v_mfma_f32_16x16x32_bf16 v[108:111], v[168:171], v[20:23], v[108:111]
    s_waitcnt lgkmcnt(4)
    v_mfma_f32_16x16x32_bf16 v[48:51], v[172:175], v[160:163], v[48:51]
    s_waitcnt lgkmcnt(0)
    s_barrier
    v_mfma_f32_16x16x32_bf16 v[56:59], v[172:175], v[164:167], v[56:59]
    ds_read_b128 v[192:195], v12 offset:0
    ds_read_b128 v[196:199], v12 offset:2048
    v_mfma_f32_16x16x32_bf16 v[112:115], v[172:175], v[20:23], v[112:115]
    ds_read_b128 v[200:203], v12 offset:4096
    ds_read_b64_tr_b16 v[212:213], v18 offset:8192
    v_mfma_f32_16x16x32_bf16 v[84:87], v[156:159], v[184:187], v[84:87]
    ds_read_b64_tr_b16 v[214:215], v18 offset:8704
    ds_read_b64_tr_b16 v[216:217], v19 offset:8192
    v_mfma_f32_16x16x32_bf16 v[92:95], v[160:163], v[184:187], v[92:95]
    ds_read_b64_tr_b16 v[218:219], v19 offset:8704
    ds_read_b64_tr_b16 v[204:205], v18 offset:0
    v_mfma_f32_16x16x32_bf16 v[100:103], v[164:167], v[184:187], v[100:103]
    ds_read_b64_tr_b16 v[206:207], v18 offset:512
    ds_read_b64_tr_b16 v[208:209], v19 offset:0
    v_mfma_f32_16x16x32_bf16 v[124:127], v[20:23], v[184:187], v[124:127]
    ds_read_b64_tr_b16 v[210:211], v19 offset:512
    ds_read_b64_tr_b16 v[220:221], v18 offset:16384
    v_mfma_f32_16x16x32_bf16 v[88:91], v[156:159], v[188:191], v[88:91]
    ds_read_b64_tr_b16 v[222:223], v18 offset:16896
    ds_read_b64_tr_b16 v[224:225], v19 offset:16384
    v_mfma_f32_16x16x32_bf16 v[96:99], v[160:163], v[188:191], v[96:99]
    ds_read_b64_tr_b16 v[226:227], v19 offset:16896
    v_mfma_f32_16x16x32_bf16 v[104:107], v[164:167], v[188:191], v[104:107]
    v_mfma_f32_16x16x32_bf16 v[128:131], v[20:23], v[188:191], v[128:131]
    s_waitcnt lgkmcnt(14)
    v_mfma_f32_16x16x32_bf16 v[132:135], v[20:23], v[192:195], v[132:135]
    v_mfma_f32_16x16x32_bf16 v[144:147], v[192:195], v[192:195], v[144:147]
    s_waitcnt lgkmcnt(13)
    v_mfma_f32_16x16x32_bf16 v[136:139], v[20:23], v[196:199], v[136:139]
    v_mfma_f32_16x16x32_bf16 v[148:151], v[196:199], v[196:199], v[148:151]
    s_waitcnt lgkmcnt(12)
    v_mfma_f32_16x16x32_bf16 v[140:143], v[20:23], v[200:203], v[140:143]
    ds_read_b128 v[156:159], v13 offset:0
    v_mfma_f32_16x16x32_bf16 v[152:155], v[200:203], v[200:203], v[152:155]
    ds_read_b128 v[160:163], v13 offset:2048
    s_waitcnt lgkmcnt(12)
    v_mfma_f32_16x16x32_bf16 v[60:63], v[212:215], v[192:195], v[60:63]
    ds_read_b128 v[164:167], v13 offset:4096
    v_mfma_f32_16x16x32_bf16 v[68:71], v[212:215], v[196:199], v[68:71]
    ds_read_b64_tr_b16 v[176:177], v18 offset:12288
    v_mfma_f32_16x16x32_bf16 v[76:79], v[212:215], v[200:203], v[76:79]
    ds_read_b64_tr_b16 v[178:179], v18 offset:12800
    v_mfma_f32_16x16x32_bf16 v[116:119], v[212:215], v[20:23], v[116:119]
    ds_read_b64_tr_b16 v[180:181], v19 offset:12288
    s_waitcnt lgkmcnt(14)
    v_mfma_f32_16x16x32_bf16 v[64:67], v[216:219], v[192:195], v[64:67]
    ds_read_b64_tr_b16 v[182:183], v19 offset:12800
    v_mfma_f32_16x16x32_bf16 v[72:75], v[216:219], v[196:199], v[72:75]
    ds_read_b64_tr_b16 v[168:169], v18 offset:4096
    v_mfma_f32_16x16x32_bf16 v[80:83], v[216:219], v[200:203], v[80:83]
    ds_read_b64_tr_b16 v[170:171], v18 offset:4608
    v_mfma_f32_16x16x32_bf16 v[120:123], v[216:219], v[20:23], v[120:123]
    ds_read_b64_tr_b16 v[172:173], v19 offset:4096
    s_waitcnt lgkmcnt(15)
    v_mfma_f32_16x16x32_bf16 v[44:47], v[204:207], v[196:199], v[44:47]
    ds_read_b64_tr_b16 v[174:175], v19 offset:4608
    v_mfma_f32_16x16x32_bf16 v[52:55], v[204:207], v[200:203], v[52:55]
    ds_read_b64_tr_b16 v[184:185], v18 offset:20480
    v_mfma_f32_16x16x32_bf16 v[108:111], v[204:207], v[20:23], v[108:111]
    ds_read_b64_tr_b16 v[186:187], v18 offset:20992
    s_waitcnt lgkmcnt(15)
    v_mfma_f32_16x16x32_bf16 v[48:51], v[208:211], v[196:199], v[48:51]
    ds_read_b64_tr_b16 v[188:189], v19 offset:20480
    v_mfma_f32_16x16x32_bf16 v[56:59], v[208:211], v[200:203], v[56:59]
    ds_read_b64_tr_b16 v[190:191], v19 offset:20992
    v_mfma_f32_16x16x32_bf16 v[112:115], v[208:211], v[20:23], v[112:115]
    v_mfma_f32_16x16x32_bf16 v[84:87], v[192:195], v[220:223], v[84:87]
    v_mfma_f32_16x16x32_bf16 v[92:95], v[196:199], v[220:223], v[92:95]
    v_mfma_f32_16x16x32_bf16 v[100:103], v[200:203], v[220:223], v[100:103]
    v_mfma_f32_16x16x32_bf16 v[124:127], v[20:23], v[220:223], v[124:127]
    s_waitcnt lgkmcnt(15)
    v_mfma_f32_16x16x32_bf16 v[88:91], v[192:195], v[224:227], v[88:91]
    v_mfma_f32_16x16x32_bf16 v[96:99], v[196:199], v[224:227], v[96:99]
    v_mfma_f32_16x16x32_bf16 v[104:107], v[200:203], v[224:227], v[104:107]
    v_mfma_f32_16x16x32_bf16 v[128:131], v[20:23], v[224:227], v[128:131]
    s_waitcnt lgkmcnt(14)
    v_mfma_f32_16x16x32_bf16 v[132:135], v[20:23], v[156:159], v[132:135]
    v_mfma_f32_16x16x32_bf16 v[144:147], v[156:159], v[156:159], v[144:147]
    s_waitcnt lgkmcnt(13)
    v_mfma_f32_16x16x32_bf16 v[136:139], v[20:23], v[160:163], v[136:139]
    v_mfma_f32_16x16x32_bf16 v[148:151], v[160:163], v[160:163], v[148:151]
    s_waitcnt lgkmcnt(12)
    v_mfma_f32_16x16x32_bf16 v[140:143], v[20:23], v[164:167], v[140:143]
    v_mfma_f32_16x16x32_bf16 v[152:155], v[164:167], v[164:167], v[152:155]
    s_waitcnt lgkmcnt(10)
    v_mfma_f32_16x16x32_bf16 v[60:63], v[176:179], v[156:159], v[60:63]
    v_mfma_f32_16x16x32_bf16 v[68:71], v[176:179], v[160:163], v[68:71]
    v_mfma_f32_16x16x32_bf16 v[76:79], v[176:179], v[164:167], v[76:79]
    v_mfma_f32_16x16x32_bf16 v[116:119], v[176:179], v[20:23], v[116:119]
    s_waitcnt lgkmcnt(8)
    v_mfma_f32_16x16x32_bf16 v[64:67], v[180:183], v[156:159], v[64:67]
    v_mfma_f32_16x16x32_bf16 v[72:75], v[180:183], v[160:163], v[72:75]
    v_mfma_f32_16x16x32_bf16 v[80:83], v[180:183], v[164:167], v[80:83]
    v_mfma_f32_16x16x32_bf16 v[120:123], v[180:183], v[20:23], v[120:123]
    s_waitcnt lgkmcnt(6)
    v_mfma_f32_16x16x32_bf16 v[44:47], v[168:171], v[160:163], v[44:47]
    v_mfma_f32_16x16x32_bf16 v[52:55], v[168:171], v[164:167], v[52:55]
    v_mfma_f32_16x16x32_bf16 v[108:111], v[168:171], v[20:23], v[108:111]
    s_waitcnt lgkmcnt(4)
    v_mfma_f32_16x16x32_bf16 v[48:51], v[172:175], v[160:163], v[48:51]
    s_branch PG_67
.p2align 12
STUB_x5:
    s_setpc_b64 s[6:7]
    s_nop 0
PG_67:
    s_waitcnt lgkmcnt(0)
    s_barrier
    v_mfma_f32_16x16x32_bf16 v[56:59], v[172:175], v[164:167], v[56:59]
    ds_read_b128 v[192:195], v8 offset:0
    ds_read_b128 v[196:199], v8 offset:2048
    v_mfma_f32_16x16x32_bf16 v[112:115], v[172:175], v[20:23], v[112:115]
    ds_read_b128 v[200:203], v8 offset:4096
    ds_read_b64_tr_b16 v[212:213], v14 offset:8192
    v_mfma_f32_16x16x32_bf16 v[84:87], v[156:159], v[184:187], v[84:87]
    ds_read_b64_tr_b16 v[214:215], v14 offset:8704
    ds_read_b64_tr_b16 v[216:217], v15 offset:8192
    v_mfma_f32_16x16x32_bf16 v[92:95], v[160:163], v[184:187], v[92:95]
    ds_read_b64_tr_b16 v[218:219], v15 offset:8704
    ds_read_b64_tr_b16 v[204:205], v14 offset:0
    v_mfma_f32_16x16x32_bf16 v[100:103], v[164:167], v[184:187], v[100:103]
    ds_read_b64_tr_b16 v[206:207], v14 offset:512
    ds_read_b64_tr_b16 v[208:209], v15 offset:0
    v_mfma_f32_16x16x32_bf16 v[124:127], v[20:23], v[184:187], v[124:127]
    ds_read_b64_tr_b16 v[210:211], v15 offset:512
    ds_read_b64_tr_b16 v[220:221], v14 offset:16384
    v_mfma_f32_16x16x32_bf16 v[88:91], v[156:159], v[188:191], v[88:91]
    ds_read_b64_tr_b16 v[222:223], v14 offset:16896
    ds_read_b64_tr_b16 v[224:225], v15 offset:16384
    v_mfma_f32_16x16x32_bf16 v[96:99], v[160:163], v[188:191], v[96:99]
    ds_read_b64_tr_b16 v[226:227], v15 offset:16896
    v_mfma_f32_16x16x32_bf16 v[104:107], v[164:167], v[188:191], v[104:107]
    v_mfma_f32_16x16x32_bf16 v[128:131], v[20:23], v[188:191], v[128:131]
    s_waitcnt vmcnt(0)
    ds_read_b128 v[156:159], v9 offset:0
    ds_read_b128 v[160:163], v9 offset:2048
    ds_read_b128 v[164:167], v9 offset:4096
    v_mov_b32 v3, 0
    buffer_load_dword v4, v3, s[40:43], 0 offen sc1
    s_waitcnt lgkmcnt(15)
    v_mfma_f32_16x16x32_bf16 v[132:135], v[20:23], v[192:195], v[132:135]
    v_mfma_f32_16x16x32_bf16 v[144:147], v[192:195], v[192:195], v[144:147]
    v_mfma_f32_16x16x32_bf16 v[136:139], v[20:23], v[196:199], v[136:139]
    v_mfma_f32_16x16x32_bf16 v[148:151], v[196:199], v[196:199], v[148:151]
    v_mfma_f32_16x16x32_bf16 v[140:143], v[20:23], v[200:203], v[140:143]
    v_mfma_f32_16x16x32_bf16 v[152:155], v[200:203], v[200:203], v[152:155]
    s_waitcnt lgkmcnt(13)
    v_mfma_f32_16x16x32_bf16 v[60:63], v[212:215], v[192:195], v[60:63]
    v_mfma_f32_16x16x32_bf16 v[68:71], v[212:215], v[196:199], v[68:71]
    v_mfma_f32_16x16x32_bf16 v[76:79], v[212:215], v[200:203], v[76:79]
    v_mfma_f32_16x16x32_bf16 v[116:119], v[212:215], v[20:23], v[116:119]
    s_waitcnt lgkmcnt(2)
    v_mfma_f32_16x16x32_bf16 v[132:135], v[20:23], v[156:159], v[132:135]
    v_mfma_f32_16x16x32_bf16 v[144:147], v[156:159], v[156:159], v[144:147]
    s_waitcnt lgkmcnt(1)
    v_mfma_f32_16x16x32_bf16 v[136:139], v[20:23], v[160:163], v[136:139]
    v_mfma_f32_16x16x32_bf16 v[148:151], v[160:163], v[160:163], v[148:151]
    s_waitcnt lgkmcnt(0)
    v_mfma_f32_16x16x32_bf16 v[140:143], v[20:23], v[164:167], v[140:143]
    v_mfma_f32_16x16x32_bf16 v[152:155], v[164:167], v[164:167], v[152:155]
    v_mfma_f32_16x16x32_bf16 v[64:67], v[216:219], v[192:195], v[64:67]
    v_mfma_f32_16x16x32_bf16 v[72:75], v[216:219], v[196:199], v[72:75]
    v_mfma_f32_16x16x32_bf16 v[80:83], v[216:219], v[200:203], v[80:83]
    v_cndmask_b32 v144, v144, v145, s[60:61]
    s_nop 0
    v_cndmask_b32 v148, v148, v149, s[60:61]
    v_mfma_f32_16x16x32_bf16 v[120:123], v[216:219], v[20:23], v[120:123]
    s_nop 0
    v_cndmask_b32 v152, v152, v153, s[60:61]
    v_cndmask_b32 v146, v146, v147, s[60:61]
    v_mfma_f32_16x16x32_bf16 v[44:47], v[204:207], v[196:199], v[44:47]
    v_cndmask_b32 v150, v150, v151, s[60:61]
    v_cndmask_b32 v154, v154, v155, s[60:61]
    v_mfma_f32_16x16x32_bf16 v[52:55], v[204:207], v[200:203], v[52:55]
    v_mul_f32 v134, 0xbb124925, v132
    v_mul_f32 v138, 0xbb124925, v136
    v_mfma_f32_16x16x32_bf16 v[108:111], v[204:207], v[20:23], v[108:111]
    v_mul_f32 v142, 0xbb124925, v140
    v_cndmask_b32 v144, v144, v146, s[62:63]
    v_mfma_f32_16x16x32_bf16 v[48:51], v[208:211], v[196:199], v[48:51]
    v_cndmask_b32 v148, v148, v150, s[62:63]
    v_cndmask_b32 v152, v152, v154, s[62:63]
    v_mfma_f32_16x16x32_bf16 v[56:59], v[208:211], v[200:203], v[56:59]
    v_mul_f32 v144, 0x3b124925, v144
    v_mul_f32 v148, 0x3b124925, v148
    v_mfma_f32_16x16x32_bf16 v[112:115], v[208:211], v[20:23], v[112:115]
    v_mul_f32 v152, 0x3b124925, v152
    v_fma_f32 v144, -v134, v134, v144
    s_barrier
    v_mfma_f32_16x16x32_bf16 v[84:87], v[192:195], v[220:223], v[84:87]
    ds_read_b64_tr_b16 v[176:177], v14 offset:12288
    ds_read_b64_tr_b16 v[178:179], v14 offset:12800
    v_fma_f32 v148, -v138, v138, v148
    v_fma_f32 v152, -v142, v142, v152
    v_mfma_f32_16x16x32_bf16 v[92:95], v[196:199], v[220:223], v[92:95]
    ds_read_b64_tr_b16 v[180:181], v15 offset:12288
    ds_read_b64_tr_b16 v[182:183], v15 offset:12800
    v_max_f32 v144, 0, v144
    v_max_f32 v148, 0, v148
    v_mfma_f32_16x16x32_bf16 v[100:103], v[200:203], v[220:223], v[100:103]
    ds_read_b64_tr_b16 v[168:169], v14 offset:4096
    ds_read_b64_tr_b16 v[170:171], v14 offset:4608
    v_max_f32 v152, 0, v152
    v_add_f32 v144, 0x3727c5ac, v144
    v_mfma_f32_16x16x32_bf16 v[124:127], v[20:23], v[220:223], v[124:127]
    ds_read_b64_tr_b16 v[172:173], v15 offset:4096
    ds_read_b64_tr_b16 v[174:175], v15 offset:4608
    v_add_f32 v148, 0x3727c5ac, v148
    v_add_f32 v152, 0x3727c5ac, v152
    v_mfma_f32_16x16x32_bf16 v[88:91], v[192:195], v[224:227], v[88:91]
    ds_read_b64_tr_b16 v[184:185], v14 offset:20480
    ds_read_b64_tr_b16 v[186:187], v14 offset:20992
    v_rsq_f32 v135, v144
    v_rsq_f32 v139, v148
    v_mfma_f32_16x16x32_bf16 v[96:99], v[196:199], v[224:227], v[96:99]
    ds_read_b64_tr_b16 v[188:189], v15 offset:20480
    ds_read_b64_tr_b16 v[190:191], v15 offset:20992
    v_rsq_f32 v143, v152
    s_mov_b64 exec, s[68:69]
    ds_write2_b32 v38, v134, v135 offset0:0 offset1:16
    ds_write2_b32 v38, v138, v139 offset0:32 offset1:48
    ds_write2_b32 v38, v142, v143 offset0:64 offset1:80
    s_mov_b64 exec, -1
    v_mfma_f32_16x16x32_bf16 v[104:107], v[200:203], v[224:227], v[104:107]
    v_mfma_f32_16x16x32_bf16 v[128:131], v[20:23], v[224:227], v[128:131]
    s_waitcnt lgkmcnt(13)
    v_mfma_f32_16x16x32_bf16 v[60:63], v[176:179], v[156:159], v[60:63]
    ds_read_b32 v137, v38 offset:192
    ds_read_b32 v141, v38 offset:320
    v_mfma_f32_16x16x32_bf16 v[68:71], v[176:179], v[160:163], v[68:71]
    ds_read_b32 v24, v40 offset:64
    ds_read_b32 v25, v41 offset:72
    v_mfma_f32_16x16x32_bf16 v[76:79], v[176:179], v[164:167], v[76:79]
    ds_read_b32 v26, v40 offset:192
    ds_read_b32 v27, v41 offset:200
    v_mfma_f32_16x16x32_bf16 v[116:119], v[176:179], v[20:23], v[116:119]
    ds_read_b128 v[144:147], v39 offset:0
    ds_read_b128 v[148:151], v39 offset:128
    s_waitcnt lgkmcnt(15)
    v_mfma_f32_16x16x32_bf16 v[64:67], v[180:183], v[156:159], v[64:67]
    ds_read_b128 v[152:155], v39 offset:256
    v_mfma_f32_16x16x32_bf16 v[72:75], v[180:183], v[160:163], v[72:75]
    v_mfma_f32_16x16x32_bf16 v[80:83], v[180:183], v[164:167], v[80:83]
    v_mfma_f32_16x16x32_bf16 v[120:123], v[180:183], v[20:23], v[120:123]
    v_mfma_f32_16x16x32_bf16 v[44:47], v[168:171], v[160:163], v[44:47]
    v_fmac_f32 v60, v116, v134
    v_fmac_f32 v61, v117, v134
    v_mfma_f32_16x16x32_bf16 v[52:55], v[168:171], v[164:167], v[52:55]
    v_fmac_f32 v62, v118, v134
    v_fmac_f32 v63, v119, v134
    v_mfma_f32_16x16x32_bf16 v[108:111], v[168:171], v[20:23], v[108:111]
    v_fmac_f32 v68, v116, v138
    v_fmac_f32 v69, v117, v138
    v_mfma_f32_16x16x32_bf16 v[48:51], v[172:175], v[160:163], v[48:51]
    v_fmac_f32 v70, v118, v138
    v_fmac_f32 v71, v119, v138
    v_mfma_f32_16x16x32_bf16 v[56:59], v[172:175], v[164:167], v[56:59]
    v_fmac_f32 v76, v116, v142
    v_fmac_f32 v77, v117, v142
    v_mfma_f32_16x16x32_bf16 v[112:115], v[172:175], v[20:23], v[112:115]
    v_fmac_f32 v78, v118, v142
    v_fmac_f32 v79, v119, v142
    s_waitcnt lgkmcnt(14)
    v_mfma_f32_16x16x32_bf16 v[84:87], v[156:159], v[184:187], v[84:87]
    v_cvt_pk_bf16_f32 v192, v60, v61
    v_cvt_pk_bf16_f32 v193, v62, v63
    v_mfma_f32_16x16x32_bf16 v[92:95], v[160:163], v[184:187], v[92:95]
    v_cvt_pk_bf16_f32 v196, v68, v69
    v_cvt_pk_bf16_f32 v197, v70, v71
    v_mfma_f32_16x16x32_bf16 v[100:103], v[164:167], v[184:187], v[100:103]
    v_cvt_pk_bf16_f32 v200, v76, v77
    v_cvt_pk_bf16_f32 v201, v78, v79
    v_mfma_f32_16x16x32_bf16 v[124:127], v[20:23], v[184:187], v[124:127]
    v_fmac_f32 v64, v120, v134
    v_fmac_f32 v65, v121, v134
    s_waitcnt lgkmcnt(12)
    v_mfma_f32_16x16x32_bf16 v[88:91], v[156:159], v[188:191], v[88:91]
    v_fmac_f32 v66, v122, v134
    v_fmac_f32 v67, v123, v134
    v_mfma_f32_16x16x32_bf16 v[96:99], v[160:163], v[188:191], v[96:99]
    v_fmac_f32 v72, v120, v138
    v_fmac_f32 v73, v121, v138
    v_mfma_f32_16x16x32_bf16 v[104:107], v[164:167], v[188:191], v[104:107]
    v_fmac_f32 v74, v122, v138
    v_fmac_f32 v75, v123, v138
    v_mfma_f32_16x16x32_bf16 v[128:131], v[20:23], v[188:191], v[128:131]
    v_fmac_f32 v80, v120, v142
    v_fmac_f32 v81, v121, v142
    v_fmac_f32 v82, v122, v142
    v_fmac_f32 v83, v123, v142
    v_cvt_pk_bf16_f32 v194, v64, v65
    v_cvt_pk_bf16_f32 v195, v66, v67
    v_cvt_pk_bf16_f32 v198, v72, v73
    v_cvt_pk_bf16_f32 v199, v74, v75
    v_cvt_pk_bf16_f32 v202, v80, v81
    v_cvt_pk_bf16_f32 v203, v82, v83
    v_fmac_f32 v44, v108, v138
    v_fmac_f32 v45, v109, v138
    v_fmac_f32 v46, v110, v138
    v_fmac_f32 v47, v111, v138
    v_fmac_f32 v52, v108, v142
    v_fmac_f32 v53, v109, v142
    v_fmac_f32 v54, v110, v142
    v_fmac_f32 v55, v111, v142
    v_cvt_pk_bf16_f32 v204, v44, v45
    v_cvt_pk_bf16_f32 v205, v46, v47
    v_cvt_pk_bf16_f32 v208, v52, v53
    v_cvt_pk_bf16_f32 v209, v54, v55
    v_fmac_f32 v48, v112, v138
    v_fmac_f32 v49, v113, v138
    v_fmac_f32 v50, v114, v138
    v_fmac_f32 v51, v115, v138
    v_fmac_f32 v56, v112, v142
    v_fmac_f32 v57, v113, v142
    v_fmac_f32 v58, v114, v142
    v_fmac_f32 v59, v115, v142
    v_cvt_pk_bf16_f32 v206, v48, v49
    v_cvt_pk_bf16_f32 v207, v50, v51
    v_cvt_pk_bf16_f32 v210, v56, v57
    v_cvt_pk_bf16_f32 v211, v58, v59
    v_and_b32 v206, v206, v37
    v_and_b32 v207, v207, v37
    v_and_b32 v210, v210, v37
    v_and_b32 v211, v211, v37
    v_mfma_f32_16x16x32_bf16 v[156:159], v[192:195], v[204:207], 0
    v_mfma_f32_16x16x32_bf16 v[164:167], v[196:199], v[204:207], 0
    v_mfma_f32_16x16x32_bf16 v[160:163], v[196:199], v[208:211], 0
    v_mfma_f32_16x16x32_bf16 v[168:171], v[200:203], v[208:211], 0
    s_waitcnt lgkmcnt(8)
    v_mul_f32 v139, 0x3e8b97f6, v137
    s_waitcnt lgkmcnt(7)
    v_mul_f32 v143, 0x3e8b97f6, v141
    s_waitcnt lgkmcnt(6)
    v_mul_f32 v28, v24, v139
    s_waitcnt lgkmcnt(5)
    v_mul_f32 v29, v25, v139
    s_waitcnt lgkmcnt(4)
    v_mul_f32 v30, v26, v143
    s_waitcnt lgkmcnt(3)
    v_mul_f32 v31, v27, v143
    s_waitcnt lgkmcnt(2)
    v_pk_fma_f32 v[84:85], v[144:145], v[124:125], v[84:85]
    v_pk_fma_f32 v[86:87], v[146:147], v[124:125], v[86:87]
    s_waitcnt lgkmcnt(1)
    v_pk_fma_f32 v[92:93], v[148:149], v[124:125], v[92:93]
    v_pk_fma_f32 v[94:95], v[150:151], v[124:125], v[94:95]
    v_cndmask_b32 v156, v156, v157, s[60:61]
    v_cndmask_b32 v160, v160, v161, s[60:61]
    v_cndmask_b32 v158, v158, v159, s[60:61]
    v_cndmask_b32 v162, v162, v163, s[60:61]
    v_cndmask_b32 v164, v164, v165, s[60:61]
    v_cndmask_b32 v168, v168, v169, s[60:61]
    v_cndmask_b32 v166, v166, v167, s[60:61]
    v_cndmask_b32 v170, v170, v171, s[60:61]
    v_cndmask_b32 v156, v156, v164, s[64:65]
    v_cndmask_b32 v160, v160, v168, s[64:65]
    v_cndmask_b32 v158, v158, v166, s[66:67]
    v_cndmask_b32 v162, v162, v170, s[66:67]
    v_fma_f32 v156, v156, v28, v42
    v_fma_f32 v160, v160, v30, 0
    v_fma_f32 v158, v158, v29, v43
    v_fma_f32 v162, v162, v31, 0
    s_waitcnt lgkmcnt(0)
    v_pk_fma_f32 v[100:101], v[152:153], v[124:125], v[100:101]
    v_max_f32 v173, v156, v158
    v_max_f32 v174, v160, v162
    v_max_f32 v177, v156, v158
    v_max_f32 v178, v160, v162
    v_pk_fma_f32 v[102:103], v[154:155], v[124:125], v[102:103]
    v_permlane32_swap_b32 v173, v177
    v_permlane32_swap_b32 v174, v178
    v_cvt_pk_bf16_f32 v212, v84, v85
    v_cvt_pk_bf16_f32 v213, v86, v87
    v_max_f32 v157, v173, v177
    v_max_f32 v161, v174, v178
    v_max_f32 v159, v173, v177
    v_max_f32 v163, v174, v178
    v_cvt_pk_bf16_f32 v214, v92, v93
    v_permlane16_swap_b32 v157, v159
    v_permlane16_swap_b32 v161, v163
    v_cvt_pk_bf16_f32 v215, v94, v95
    v_cvt_pk_bf16_f32 v216, v100, v101
    v_max_f32 v173, v157, v159
    v_max_f32 v174, v161, v163
    v_cvt_pk_bf16_f32 v217, v102, v103
    v_sub_f32 v156, v156, v173
    v_sub_f32 v160, v160, v174
    v_sub_f32 v158, v158, v173
    v_sub_f32 v162, v162, v174
    v_exp_f32 v156, v156
    v_exp_f32 v160, v160
    v_exp_f32 v158, v158
    v_exp_f32 v162, v162
    v_pk_fma_f32 v[88:89], v[144:145], v[128:129], v[88:89]
    v_pk_fma_f32 v[90:91], v[146:147], v[128:129], v[90:91]
    v_add_f32 v173, v156, v158
    v_add_f32 v174, v160, v162
    v_add_f32 v177, v156, v158
    v_add_f32 v178, v160, v162
    v_pk_fma_f32 v[96:97], v[148:149], v[128:129], v[96:97]
    v_permlane32_swap_b32 v173, v177
    v_permlane32_swap_b32 v174, v178
    v_mul_f32 v156, v156, v24
    v_mul_f32 v160, v160, v26
    v_add_f32 v157, v173, v177
    v_add_f32 v161, v174, v178
    v_add_f32 v159, v173, v177
    v_add_f32 v163, v174, v178
    v_pk_fma_f32 v[98:99], v[150:151], v[128:129], v[98:99]
    v_permlane16_swap_b32 v157, v159
    v_permlane16_swap_b32 v161, v163
    v_mul_f32 v158, v158, v25
    v_mul_f32 v162, v162, v27
    v_add_f32 v173, v157, v159
    v_add_f32 v174, v161, v163
    v_pk_fma_f32 v[104:105], v[152:153], v[128:129], v[104:105]
    v_pk_fma_f32 v[106:107], v[154:155], v[128:129], v[106:107]
    v_rcp_f32 v173, v173
    v_rcp_f32 v174, v174
    v_cvt_pk_bf16_f32 v218, v88, v89
    v_cvt_pk_bf16_f32 v219, v90, v91
    v_cvt_pk_bf16_f32 v220, v96, v97
    v_mul_f32 v156, v156, v173
    v_mul_f32 v160, v160, v174
    v_mul_f32 v158, v158, v173
    v_mul_f32 v162, v162, v174
    v_cvt_pk_bf16_f32 v221, v98, v99
    v_cvt_pk_bf16_f32 v156, v156, v156
    v_cvt_pk_bf16_f32 v160, v160, v160
    v_cvt_pk_bf16_f32 v158, v158, v158
    v_cvt_pk_bf16_f32 v162, v162, v162
    v_cvt_pk_bf16_f32 v222, v104, v105
    v_cvt_pk_bf16_f32 v223, v106, v107
    v_and_b32 v164, v156, v33
    v_and_b32 v168, v160, v33
    v_and_b32 v165, v158, v34
    v_and_b32 v169, v162, v34
    v_and_b32 v166, v156, v35
    v_and_b32 v170, v160, v35
    v_and_b32 v167, v158, v36
    v_and_b32 v171, v162, v36
    s_cmp_ge_u32 s46, 28
    s_cbranch_scc1 XNB7
    s_barrier
XNB7:
    v_mfma_f32_16x16x32_bf16 v[68:71], v[212:215], v[164:167], 0
    v_mfma_f32_16x16x32_bf16 v[72:75], v[218:221], v[164:167], 0
    v_mfma_f32_16x16x32_bf16 v[76:79], v[214:217], v[168:171], 0
    v_mfma_f32_16x16x32_bf16 v[80:83], v[220:223], v[168:171], 0
    s_nop 4
    v_cvt_pk_bf16_f32 v156, v68, v69
    v_cvt_pk_bf16_f32 v157, v70, v71
    v_cvt_pk_bf16_f32 v158, v72, v73
    v_cvt_pk_bf16_f32 v159, v74, v75
    v_and_b32 v158, v158, v37
    v_and_b32 v159, v159, v37
    buffer_store_dwordx4 v[156:159], v2, s[36:39], s58 offen sc1
    v_cvt_pk_bf16_f32 v160, v76, v77
    v_cvt_pk_bf16_f32 v161, v78, v79
    v_cvt_pk_bf16_f32 v162, v80, v81
    v_cvt_pk_bf16_f32 v163, v82, v83
    v_and_b32 v162, v162, v37
    v_and_b32 v163, v163, v37
    buffer_store_dwordx4 v[160:163], v2, s[36:39], s59 offen sc1
    s_waitcnt vmcnt(2)
    v_readfirstlane_b32 s47, v4
    s_waitcnt vmcnt(0)
    s_mov_b64 exec, 1
    v_mov_b32 v4, s47
    s_lshl_b32 s6, s44, 2
    v_mov_b32 v5, s6
    s_add_u32 s6, s57, 32768
    buffer_store_dword v4, v5, s[36:39], s6 offen
    s_mov_b64 exec, -1
    s_branch PG_68
.p2align 12
STUB_xm:
    s_setpc_b64 s[6:7]
    s_nop 0
PG_68:
    s_barrier
    s_cmp_lt_u32 s46, 28
    s_cbranch_scc1 XGO
    s_atomic_add s0, s[36:37], s57
    s_branch END_X
XGO:
    v_bfe_u32 v8, v1, 2, 2
    v_lshrrev_b32 v9, 4, v1
    v_lshlrev_b32 v10, 11, v9
    v_lshl_add_u32 v10, v8, 7, v10
    v_and_b32 v8, 2, v8
    v_lshlrev_b32 v8, 4, v8
    v_and_b32 v11, 1, v9
    v_lshl_or_b32 v8, v11, 6, v8
    v_and_b32 v11, 3, v1
    v_lshlrev_b32 v9, 3, v11
    s_lshl_b32 s3, s44, 5
    v_or_b32 v9, s3, v9
    v_xor_b32 v9, v9, v8
    v_add_u32 v15, v9, v10
    v_add_u32 v13, 57344, v15
    v_add_u32 v14, 122880, v15
    ds_read_b64_tr_b16 v[28:29], v13 offset:0
    ds_read_b64_tr_b16 v[30:31], v13 offset:512
    ds_read_b64_tr_b16 v[32:33], v13 offset:1024
    ds_read_b64_tr_b16 v[34:35], v13 offset:1536
    ds_read_b64_tr_b16 v[36:37], v13 offset:8192
    ds_read_b64_tr_b16 v[38:39], v13 offset:8704
    ds_read_b64_tr_b16 v[40:41], v13 offset:9216
    ds_read_b64_tr_b16 v[42:43], v13 offset:9728
    ds_read_b64_tr_b16 v[44:45], v13 offset:16384
    ds_read_b64_tr_b16 v[46:47], v13 offset:16896
    ds_read_b64_tr_b16 v[48:49], v13 offset:17408
    ds_read_b64_tr_b16 v[50:51], v13 offset:17920
    ds_read_b64_tr_b16 v[52:53], v13 offset:24576
    ds_read_b64_tr_b16 v[54:55], v13 offset:25088
    ds_read_b64_tr_b16 v[56:57], v13 offset:25600
    ds_read_b64_tr_b16 v[58:59], v13 offset:26112
    ds_read_b64_tr_b16 v[60:61], v13 offset:32768
    ds_read_b64_tr_b16 v[62:63], v13 offset:33280
    ds_read_b64_tr_b16 v[64:65], v13 offset:33792
    ds_read_b64_tr_b16 v[66:67], v13 offset:34304
    ds_read_b64_tr_b16 v[68:69], v13 offset:40960
    ds_read_b64_tr_b16 v[70:71], v13 offset:41472
    ds_read_b64_tr_b16 v[72:73], v13 offset:41984
    ds_read_b64_tr_b16 v[74:75], v13 offset:42496
    ds_read_b64_tr_b16 v[76:77], v13 offset:49152
    ds_read_b64_tr_b16 v[78:79], v13 offset:49664
    ds_read_b64_tr_b16 v[80:81], v13 offset:50176
    ds_read_b64_tr_b16 v[82:83], v13 offset:50688
    ds_read_b64_tr_b16 v[84:85], v13 offset:57344
    ds_read_b64_tr_b16 v[86:87], v13 offset:57856
    ds_read_b64_tr_b16 v[88:89], v13 offset:58368
    ds_read_b64_tr_b16 v[90:91], v13 offset:58880
    v_lshrrev_b32 v8, 4, v1
    v_lshl_add_u32 v18, v8, 8, v2
    v_and_b32 v12, 15, v1
    v_lshlrev_b32 v12, 2, v12
    v_add_u32 v12, 118784, v12
    v_mov_b32 v20, 0x3f803f80
    v_mov_b32 v21, 0x3f803f80
    v_mov_b32 v22, 0x3f803f80
    v_mov_b32 v23, 0x3f803f80
    v_lshrrev_b32 v8, 3, v1
    v_and_b32 v9, 7, v1
    v_and_b32 v10, 2, v8
    v_lshlrev_b32 v10, 1, v10
    v_xor_b32 v9, v9, v10
    v_mul_u32_u24 v8, 896, v8
    v_lshl_add_u32 v140, v9, 4, v8
    s_waitcnt lgkmcnt(0)
    s_atomic_add s0, s[36:37], s57
    s_barrier
    ds_read_b64_tr_b16 v[92:93], v14 offset:0
    ds_read_b64_tr_b16 v[94:95], v14 offset:512
    ds_read_b64_tr_b16 v[96:97], v14 offset:1024
    ds_read_b64_tr_b16 v[98:99], v14 offset:1536
    ds_read_b64_tr_b16 v[100:101], v14 offset:8192
    ds_read_b64_tr_b16 v[102:103], v14 offset:8704
    ds_read_b64_tr_b16 v[104:105], v14 offset:9216
    ds_read_b64_tr_b16 v[106:107], v14 offset:9728
    ds_read_b64_tr_b16 v[108:109], v14 offset:16384
    ds_read_b64_tr_b16 v[110:111], v14 offset:16896
    ds_read_b64_tr_b16 v[112:113], v14 offset:17408
    ds_read_b64_tr_b16 v[114:115], v14 offset:17920
    ds_read_b64_tr_b16 v[116:117], v14 offset:24576
    ds_read_b64_tr_b16 v[118:119], v14 offset:25088
    ds_read_b64_tr_b16 v[120:121], v14 offset:25600
    ds_read_b64_tr_b16 v[122:123], v14 offset:26112
    ds_read_b64_tr_b16 v[124:125], v15 offset:0
    ds_read_b64_tr_b16 v[126:127], v15 offset:512
    ds_read_b64_tr_b16 v[128:129], v15 offset:1024
    ds_read_b64_tr_b16 v[130:131], v15 offset:1536
    ds_read_b64_tr_b16 v[132:133], v15 offset:8192
    ds_read_b64_tr_b16 v[134:135], v15 offset:8704
    ds_read_b64_tr_b16 v[136:137], v15 offset:9216
    ds_read_b64_tr_b16 v[138:139], v15 offset:9728
    s_and_b32 s3, s44, 1
    s_add_u32 s3, s3, s54
    s_mul_i32 s4, s3, 114688
    s_lshr_b32 s3, s44, 1
    s_mul_i32 s3, s3, 14336
    s_add_u32 s4, s4, s3
    s_add_u32 s4, s4, 4194304
    s_lshl_b32 s64, s44, 12
    s_lshl_b32 s65, s54, 11
    s_add_u32 s65, s65, 12713984
    s_sub_u32 s3, s52, 0
    s_and_b32 s3, s3, 3
    s_mul_i32 s3, s3, 28672
    s_add_u32 s60, s3, s4
    s_sub_u32 s3, s52, 1
    s_and_b32 s3, s3, 3
    s_mul_i32 s3, s3, 28672
    s_add_u32 s61, s3, s4
    s_sub_u32 s3, s52, 2
    s_and_b32 s3, s3, 3
    s_mul_i32 s3, s3, 28672
    s_add_u32 s62, s3, s4
    s_sub_u32 s3, s52, 3
    s_and_b32 s3, s3, 3
    s_mul_i32 s3, s3, 28672
    s_add_u32 s63, s3, s4
    s_lshr_b32 s3, s44, 1
    s_mul_i32 s4, s3, 200704
    s_and_b32 s3, s44, 1
    s_mul_i32 s3, s3, 28672
    s_add_u32 s4, s4, s3
    s_lshl_b32 s3, s53, 7
    s_add_u32 s4, s4, s3
    s_sub_u32 s3, s52, 0
    s_and_b32 s3, s3, 3
    s_mul_i32 s3, s3, 401408
    s_add_u32 s70, s3, s4
    s_sub_u32 s3, s52, 1
    s_and_b32 s3, s3, 3
    s_mul_i32 s3, s3, 401408
    s_add_u32 s71, s3, s4
    s_sub_u32 s3, s52, 2
    s_and_b32 s3, s3, 3
    s_mul_i32 s3, s3, 401408
    s_add_u32 s72, s3, s4
    s_sub_u32 s3, s52, 3
    s_and_b32 s3, s3, 3
    s_mul_i32 s3, s3, 401408
    s_add_u32 s73, s3, s4
    s_waitcnt lgkmcnt(0)
    s_barrier
    s_barrier
    s_add_u32 s3, s70, 0
    s_add_u32 m0, s64, 0
    s_nop 0
    buffer_load_dwordx4 v140, s[28:31], s3 offen   lds
    s_add_u32 s3, s3, 7168
    s_add_u32 m0, s64, 1024
    s_nop 0
    buffer_load_dwordx4 v140, s[28:31], s3 offen   lds
    s_add_u32 s3, s3, 7168
    s_add_u32 m0, s64, 2048
    s_nop 0
    buffer_load_dwordx4 v140, s[28:31], s3 offen   lds
    s_add_u32 s3, s3, 7168
    s_add_u32 m0, s64, 3072
    s_nop 0
    buffer_load_dwordx4 v140, s[28:31], s3 offen   lds
    s_barrier
    s_add_u32 s3, s70, 57344
    s_add_u32 m0, s64, 16384
    s_nop 0
    buffer_load_dwordx4 v140, s[28:31], s3 offen   lds
    s_add_u32 s3, s3, 7168
    s_add_u32 m0, s64, 17408
    s_nop 0
    buffer_load_dwordx4 v140, s[28:31], s3 offen   lds
    s_add_u32 s3, s3, 7168
    s_add_u32 m0, s64, 18432
    s_nop 0
    buffer_load_dwordx4 v140, s[28:31], s3 offen   lds
    s_add_u32 s3, s3, 7168
    s_add_u32 m0, s64, 19456
    s_nop 0
    buffer_load_dwordx4 v140, s[28:31], s3 offen   lds
    s_barrier
    s_add_u32 s3, s70, 114688
    s_add_u32 m0, s64, 122880
    s_nop 0
    buffer_load_dwordx4 v140, s[28:31], s3 offen   lds
    s_add_u32 s3, s3, 7168
    s_add_u32 m0, s64, 123904
    s_nop 0
    buffer_load_dwordx4 v140, s[28:31], s3 offen   lds
    s_add_u32 s3, s3, 7168
    s_add_u32 m0, s64, 124928
    s_nop 0
    buffer_load_dwordx4 v140, s[28:31], s3 offen   lds
    s_add_u32 s3, s3, 7168
    s_add_u32 m0, s64, 125952
    s_nop 0
    buffer_load_dwordx4 v140, s[28:31], s3 offen   lds
    s_add_u32 s3, s70, 172032
    s_sub_u32 s4, s71, 28672
    s_bitcmp1_b32 s44, 0
    s_cselect_b32 s3, s4, s3
    s_add_u32 m0, s64, 139264
    s_nop 0
    buffer_load_dwordx4 v140, s[28:31], s3 offen   lds
    s_add_u32 s3, s3, 7168
    s_add_u32 m0, s64, 140288
    s_nop 0
    buffer_load_dwordx4 v140, s[28:31], s3 offen   lds
    s_add_u32 s3, s3, 7168
    s_add_u32 m0, s64, 141312
    s_nop 0
    buffer_load_dwordx4 v140, s[28:31], s3 offen   lds
    s_add_u32 s3, s3, 7168
    s_add_u32 m0, s64, 142336
    s_nop 0
    buffer_load_dwordx4 v140, s[28:31], s3 offen   lds
    s_and_b32 s3, s45, 3
    s_add_u32 s3, s3, 2
    s_and_b32 s3, s3, 3
    s_lshl_b32 s4, s50, 2
    s_add_u32 s3, s3, s4
    s_lshl_b32 s3, s3, 5
    s_add_u32 s3, s3, s51
    s_lshl_b32 s3, s3, 7
    s_add_u32 s75, s3, 12713984
    s_and_b32 s3, s45, 3
    s_add_u32 s3, s3, 3
    s_and_b32 s3, s3, 3
    s_lshl_b32 s4, s50, 2
    s_add_u32 s3, s3, s4
    s_lshl_b32 s3, s3, 5
    s_add_u32 s3, s3, s51
    s_lshl_b32 s3, s3, 7
    s_add_u32 s56, s3, 12713984
    s_lshl_b32 s69, s2, 7
    s_add_u32 s69, s69, 13111296
    s_mov_b32 s68, 90112
    s_mov_b32 s67, 3
    v_add_u32 v16, 61440, v18
    s_lshl_b32 s3, s52, 1
    s_lshl_b32 s3, s3, 15
    s_lshl_b32 s59, s50, 18
    s_add_u32 s59, s59, s3
    s_lshl_b32 s74, s44, 10
    s_add_u32 s59, s59, s74
    s_add_u32 s59, s59, 2097152
    v_mov_b32 v24, s47
    v_mov_b32 v25, 0
    v_mov_b32 v228, 162184
    v_mov_b32 v229, 1
    s_and_b32 s57, s45, 3
    s_mul_i32 s57, s57, 229376
    s_lshl_b32 s3, s51, 2
    s_add_u32 s3, s3, s44
    s_lshl_b32 s3, s3, 10
    s_mul_i32 s58, s50, 917504
    s_add_u32 s58, s58, s3
    s_add_u32 s58, s58, 4194304
    s_waitcnt vmcnt(0)
    s_barrier
    v_mfma_f32_16x16x32_bf16 v[144:147], v[28:31], v[20:23], 0
    v_mfma_f32_16x16x32_bf16 v[148:151], v[32:35], v[20:23], 0
    v_mfma_f32_16x16x32_bf16 v[144:147], v[36:39], v[20:23], v[144:147]
    v_mfma_f32_16x16x32_bf16 v[148:151], v[40:43], v[20:23], v[148:151]
    v_mfma_f32_16x16x32_bf16 v[144:147], v[44:47], v[20:23], v[144:147]
    v_mfma_f32_16x16x32_bf16 v[148:151], v[48:51], v[20:23], v[148:151]
    v_mfma_f32_16x16x32_bf16 v[144:147], v[52:55], v[20:23], v[144:147]
    v_mfma_f32_16x16x32_bf16 v[148:151], v[56:59], v[20:23], v[148:151]
    s_barrier
    s_add_u32 s3, s71, 28672
    s_add_u32 m0, s64, 0
    s_nop 0
    buffer_load_dwordx4 v140, s[28:31], s3 offen   lds
    s_add_u32 s3, s3, 7168
    s_add_u32 m0, s64, 1024
    s_nop 0
    buffer_load_dwordx4 v140, s[28:31], s3 offen   lds
    s_add_u32 s3, s3, 7168
    s_add_u32 m0, s64, 2048
    s_nop 0
    buffer_load_dwordx4 v140, s[28:31], s3 offen   lds
    s_add_u32 s3, s3, 7168
    s_add_u32 m0, s64, 3072
    s_nop 0
    buffer_load_dwordx4 v140, s[28:31], s3 offen   lds
    v_mfma_f32_16x16x32_bf16 v[144:147], v[60:63], v[20:23], v[144:147]
    v_mfma_f32_16x16x32_bf16 v[148:151], v[64:67], v[20:23], v[148:151]
    v_mfma_f32_16x16x32_bf16 v[144:147], v[68:71], v[20:23], v[144:147]
    v_mfma_f32_16x16x32_bf16 v[148:151], v[72:75], v[20:23], v[148:151]
    v_mfma_f32_16x16x32_bf16 v[144:147], v[76:79], v[20:23], v[144:147]
    v_mfma_f32_16x16x32_bf16 v[148:151], v[80:83], v[20:23], v[148:151]
    v_mfma_f32_16x16x32_bf16 v[144:147], v[84:87], v[20:23], v[144:147]
    s_waitcnt vmcnt(4)
    s_add_u32 s3, s71, 86016
    s_add_u32 m0, s64, 16384
    s_nop 0
    buffer_load_dwordx4 v140, s[28:31], s3 offen   lds
    s_add_u32 s3, s3, 7168
    s_add_u32 m0, s64, 17408
    s_nop 0
    buffer_load_dwordx4 v140, s[28:31], s3 offen   lds
    s_add_u32 s3, s3, 7168
    s_add_u32 m0, s64, 18432
    s_nop 0
    buffer_load_dwordx4 v140, s[28:31], s3 offen   lds
    s_add_u32 s3, s3, 7168
    s_add_u32 m0, s64, 19456
    s_nop 0
    buffer_load_dwordx4 v140, s[28:31], s3 offen   lds
    v_mfma_f32_16x16x32_bf16 v[148:151], v[88:91], v[20:23], v[148:151]
    v_mfma_f32_16x16x32_bf16 v[144:147], v[92:95], v[20:23], v[144:147]
    v_mfma_f32_16x16x32_bf16 v[148:151], v[96:99], v[20:23], v[148:151]
    v_mfma_f32_16x16x32_bf16 v[144:147], v[100:103], v[20:23], v[144:147]
    v_mfma_f32_16x16x32_bf16 v[148:151], v[104:107], v[20:23], v[148:151]
    v_mfma_f32_16x16x32_bf16 v[144:147], v[108:111], v[20:23], v[144:147]
    v_mfma_f32_16x16x32_bf16 v[148:151], v[112:115], v[20:23], v[148:151]
    s_waitcnt vmcnt(4)
    s_add_u32 s3, s71, 143360
    s_add_u32 m0, s64, 122880
    s_nop 0
    buffer_load_dwordx4 v140, s[28:31], s3 offen   lds
    s_add_u32 s3, s3, 7168
    s_add_u32 m0, s64, 123904
    s_nop 0
    buffer_load_dwordx4 v140, s[28:31], s3 offen   lds
    s_add_u32 s3, s3, 7168
    s_add_u32 m0, s64, 124928
    s_nop 0
    buffer_load_dwordx4 v140, s[28:31], s3 offen   lds
    s_add_u32 s3, s3, 7168
    s_add_u32 m0, s64, 125952
    s_nop 0
    buffer_load_dwordx4 v140, s[28:31], s3 offen   lds
    v_mfma_f32_16x16x32_bf16 v[144:147], v[116:119], v[20:23], v[144:147]
    v_mfma_f32_16x16x32_bf16 v[148:151], v[120:123], v[20:23], v[148:151]
    v_mfma_f32_16x16x32_bf16 v[144:147], v[124:127], v[20:23], v[144:147]
    v_mfma_f32_16x16x32_bf16 v[148:151], v[128:131], v[20:23], v[148:151]
    v_mfma_f32_16x16x32_bf16 v[144:147], v[132:135], v[20:23], v[144:147]
    v_mfma_f32_16x16x32_bf16 v[148:151], v[136:139], v[20:23], v[148:151]
    s_waitcnt vmcnt(4)
    s_add_u32 s3, s72, 0
    s_add_u32 m0, s64, 139264
    s_nop 0
    buffer_load_dwordx4 v140, s[28:31], s3 offen   lds
    s_add_u32 s3, s3, 7168
    s_add_u32 m0, s64, 140288
    s_nop 0
    buffer_load_dwordx4 v140, s[28:31], s3 offen   lds
    s_add_u32 s3, s3, 7168
    s_add_u32 m0, s64, 141312
    s_nop 0
    buffer_load_dwordx4 v140, s[28:31], s3 offen   lds
    s_add_u32 s3, s3, 7168
    s_add_u32 m0, s64, 142336
    s_nop 0
    buffer_load_dwordx4 v140, s[28:31], s3 offen   lds
    v_mul_f32 v144, 0xbb124925, v144
    v_mul_f32 v145, 0xbb124925, v145
    v_mul_f32 v146, 0xbb124925, v146
    v_mul_f32 v147, 0xbb124925, v147
    v_mul_f32 v148, 0xbb124925, v148
    v_mul_f32 v149, 0xbb124925, v149
    v_mul_f32 v150, 0xbb124925, v150
    v_mul_f32 v151, 0xbb124925, v151
    s_waitcnt vmcnt(4)
    s_mov_b64 s[70:71], 0
    s_sub_u32 s6, s52, 1
    s_and_b32 s6, s6, 3
    s_mul_i32 s6, s6, 7
    s_lshl_b32 s6, 0x7f, s6
    s_or_b32 s70, s70, s6
    s_barrier
    s_add_u32 m0, s74, 61440
    s_nop 0
    buffer_load_dwordx4 v2, s[36:39], s59 offen  sc1 lds
    s_add_u32 s59, s59, 4096
    s_add_u32 m0, s74, 65536
    s_nop 0
    buffer_load_dwordx4 v2, s[36:39], s59 offen  sc1 lds
    s_add_u32 s59, s59, 4096
    s_add_u32 m0, s74, 69632
    s_nop 0
    buffer_load_dwordx4 v2, s[36:39], s59 offen  sc1 lds
    s_add_u32 s59, s59, 4096
    s_add_u32 m0, s74, 73728
    s_nop 0
    buffer_load_dwordx4 v2, s[36:39], s59 offen  sc1 lds
    s_add_u32 s59, s59, 4096
    s_add_u32 m0, s74, 77824
    s_nop 0
    buffer_load_dwordx4 v2, s[36:39], s59 offen  sc1 lds
    s_add_u32 s59, s59, 4096
    s_add_u32 m0, s74, 81920
    s_nop 0
    buffer_load_dwordx4 v2, s[36:39], s59 offen  sc1 lds
    s_add_u32 s59, s59, 4096
    s_add_u32 m0, s74, 86016
    s_nop 0
    buffer_load_dwordx4 v2, s[36:39], s59 offen  sc1 lds
    s_waitcnt vmcnt(4)
    s_barrier
    ds_read_b128 v[184:187], v16 offset:0
    ds_read_b128 v[188:191], v16 offset:256
    ds_read_b128 v[192:195], v16 offset:2048
    ds_read_b128 v[196:199], v16 offset:2304
    ds_read_b128 v[200:203], v16 offset:4096
    ds_read_b128 v[204:207], v16 offset:4352
    s_waitcnt lgkmcnt(4)
    v_mfma_f32_16x16x32_bf16 v[152:155], v[28:31], v[184:187], 0
    v_add_u32 v17, s68, v18
    s_add_u32 s68, s68, 28672
    v_mfma_f32_16x16x32_bf16 v[160:163], v[32:35], v[184:187], 0
    ds_read_b128 v[208:211], v16 offset:6144
    s_cmp_eq_u32 s68, 118784
    s_cselect_b32 s68, 32768, s68
    v_mfma_f32_16x16x32_bf16 v[156:159], v[28:31], v[188:191], 0
    v_mfma_f32_16x16x32_bf16 v[164:167], v[32:35], v[188:191], 0
    ds_read_b128 v[212:215], v16 offset:6400
    s_waitcnt lgkmcnt(4)
    v_mfma_f32_16x16x32_bf16 v[152:155], v[36:39], v[192:195], v[152:155]
    v_mfma_f32_16x16x32_bf16 v[160:163], v[40:43], v[192:195], v[160:163]
    ds_read_b128 v[184:187], v16 offset:8192
    v_mfma_f32_16x16x32_bf16 v[156:159], v[36:39], v[196:199], v[156:159]
    v_mfma_f32_16x16x32_bf16 v[164:167], v[40:43], v[196:199], v[164:167]
    ds_read_b128 v[188:191], v16 offset:8448
    s_waitcnt lgkmcnt(4)
    v_mfma_f32_16x16x32_bf16 v[152:155], v[44:47], v[200:203], v[152:155]
    v_mfma_f32_16x16x32_bf16 v[160:163], v[48:51], v[200:203], v[160:163]
    ds_read_b128 v[192:195], v16 offset:10240
    v_mfma_f32_16x16x32_bf16 v[156:159], v[44:47], v[204:207], v[156:159]
    v_mfma_f32_16x16x32_bf16 v[164:167], v[48:51], v[204:207], v[164:167]
    ds_read_b128 v[196:199], v16 offset:10496
    s_waitcnt vmcnt(0)
    s_barrier
    s_waitcnt lgkmcnt(4)
    v_mfma_f32_16x16x32_bf16 v[152:155], v[52:55], v[208:211], v[152:155]
    v_mfma_f32_16x16x32_bf16 v[160:163], v[56:59], v[208:211], v[160:163]
    ds_read_b128 v[200:203], v16 offset:12288
    v_mfma_f32_16x16x32_bf16 v[156:159], v[52:55], v[212:215], v[156:159]
    v_mfma_f32_16x16x32_bf16 v[164:167], v[56:59], v[212:215], v[164:167]
    ds_read_b128 v[204:207], v16 offset:12544
    s_waitcnt lgkmcnt(4)
    v_mfma_f32_16x16x32_bf16 v[152:155], v[60:63], v[184:187], v[152:155]
    v_mfma_f32_16x16x32_bf16 v[160:163], v[64:67], v[184:187], v[160:163]
    ds_read_b128 v[208:211], v16 offset:14336
    v_mfma_f32_16x16x32_bf16 v[156:159], v[60:63], v[188:191], v[156:159]
    v_mfma_f32_16x16x32_bf16 v[164:167], v[64:67], v[188:191], v[164:167]
    ds_read_b128 v[212:215], v16 offset:14592
    s_waitcnt lgkmcnt(4)
    v_mfma_f32_16x16x32_bf16 v[152:155], v[68:71], v[192:195], v[152:155]
    v_mfma_f32_16x16x32_bf16 v[160:163], v[72:75], v[192:195], v[160:163]
    ds_read_b128 v[184:187], v16 offset:16384
    v_mfma_f32_16x16x32_bf16 v[156:159], v[68:71], v[196:199], v[156:159]
    v_mfma_f32_16x16x32_bf16 v[164:167], v[72:75], v[196:199], v[164:167]
    ds_read_b128 v[188:191], v16 offset:16640
    s_waitcnt lgkmcnt(4)
    v_mfma_f32_16x16x32_bf16 v[152:155], v[76:79], v[200:203], v[152:155]
    v_mfma_f32_16x16x32_bf16 v[160:163], v[80:83], v[200:203], v[160:163]
    ds_read_b128 v[192:195], v16 offset:18432
    v_mfma_f32_16x16x32_bf16 v[156:159], v[76:79], v[204:207], v[156:159]
    v_mfma_f32_16x16x32_bf16 v[164:167], v[80:83], v[204:207], v[164:167]
    ds_read_b128 v[196:199], v16 offset:18688
    s_waitcnt lgkmcnt(4)
    v_mfma_f32_16x16x32_bf16 v[152:155], v[84:87], v[208:211], v[152:155]
    v_mfma_f32_16x16x32_bf16 v[160:163], v[88:91], v[208:211], v[160:163]
    ds_read_b128 v[200:203], v16 offset:20480
    v_mfma_f32_16x16x32_bf16 v[156:159], v[84:87], v[212:215], v[156:159]
    v_mfma_f32_16x16x32_bf16 v[164:167], v[88:91], v[212:215], v[164:167]
    ds_read_b128 v[204:207], v16 offset:20736
    s_waitcnt lgkmcnt(4)
    v_mfma_f32_16x16x32_bf16 v[152:155], v[92:95], v[184:187], v[152:155]
    v_mfma_f32_16x16x32_bf16 v[160:163], v[96:99], v[184:187], v[160:163]
    ds_read_b128 v[208:211], v16 offset:22528
    v_mfma_f32_16x16x32_bf16 v[156:159], v[92:95], v[188:191], v[156:159]
    v_mfma_f32_16x16x32_bf16 v[164:167], v[96:99], v[188:191], v[164:167]
    ds_read_b128 v[212:215], v16 offset:22784
    s_waitcnt lgkmcnt(4)
    v_mfma_f32_16x16x32_bf16 v[152:155], v[100:103], v[192:195], v[152:155]
    v_mfma_f32_16x16x32_bf16 v[160:163], v[104:107], v[192:195], v[160:163]
    ds_read_b128 v[184:187], v16 offset:24576
    v_mfma_f32_16x16x32_bf16 v[156:159], v[100:103], v[196:199], v[156:159]
    v_mfma_f32_16x16x32_bf16 v[164:167], v[104:107], v[196:199], v[164:167]
    ds_read_b128 v[188:191], v16 offset:24832
    s_waitcnt lgkmcnt(4)
    v_mfma_f32_16x16x32_bf16 v[152:155], v[108:111], v[200:203], v[152:155]
    v_mfma_f32_16x16x32_bf16 v[160:163], v[112:115], v[200:203], v[160:163]
    ds_read_b128 v[192:195], v16 offset:26624
    v_mfma_f32_16x16x32_bf16 v[156:159], v[108:111], v[204:207], v[156:159]
    v_mfma_f32_16x16x32_bf16 v[164:167], v[112:115], v[204:207], v[164:167]
    ds_read_b128 v[196:199], v16 offset:26880
    s_waitcnt lgkmcnt(5)
    v_mfma_f32_16x16x32_bf16 v[152:155], v[116:119], v[208:211], v[152:155]
    v_mfma_f32_16x16x32_bf16 v[160:163], v[120:123], v[208:211], v[160:163]
    s_waitcnt lgkmcnt(4)
    v_mfma_f32_16x16x32_bf16 v[156:159], v[116:119], v[212:215], v[156:159]
    v_mfma_f32_16x16x32_bf16 v[164:167], v[120:123], v[212:215], v[164:167]
    s_waitcnt lgkmcnt(3)
    v_mfma_f32_16x16x32_bf16 v[152:155], v[124:127], v[184:187], v[152:155]
    v_mfma_f32_16x16x32_bf16 v[160:163], v[128:131], v[184:187], v[160:163]
    s_branch PG_69
.p2align 12
STUB_x3:
    s_setpc_b64 s[6:7]
    s_nop 0
PG_69:
    s_waitcnt lgkmcnt(0)
    s_barrier
    ds_read2_b32 v[216:217], v12 offset0:0 offset1:16
    v_add_u32 v12, 0x80, v12
    v_mfma_f32_16x16x32_bf16 v[156:159], v[124:127], v[188:191], v[156:159]
    v_mfma_f32_16x16x32_bf16 v[164:167], v[128:131], v[188:191], v[164:167]
    ds_read_b128 v[200:203], v17 offset:0
    ds_read_b128 v[204:207], v17 offset:256
    v_mfma_f32_16x16x32_bf16 v[152:155], v[132:135], v[192:195], v[152:155]
    v_mfma_f32_16x16x32_bf16 v[160:163], v[136:139], v[192:195], v[160:163]
    ds_read_b128 v[208:211], v17 offset:2048
    ds_read_b128 v[212:215], v17 offset:2304
    v_mfma_f32_16x16x32_bf16 v[156:159], v[132:135], v[196:199], v[156:159]
    v_mfma_f32_16x16x32_bf16 v[164:167], v[136:139], v[196:199], v[164:167]
    ds_read_b128 v[184:187], v17 offset:4096
    ds_read_b128 v[188:191], v17 offset:4352
    s_sub_u32 s67, s67, 1
P3LOOP:
    s_waitcnt lgkmcnt(4)
    v_mfma_f32_16x16x32_bf16 v[168:171], v[28:31], v[200:203], 0
    s_add_u32 s55, s58, s57
    s_add_u32 s57, s57, 114688
    v_mfma_f32_16x16x32_bf16 v[176:179], v[32:35], v[200:203], 0
    ds_read_b128 v[192:195], v17 offset:6144
    s_cmp_eq_u32 s57, 917504
    s_cselect_b32 s57, 0, s57
    v_mfma_f32_16x16x32_bf16 v[172:175], v[28:31], v[204:207], 0
    v_fmac_f32 v152, v144, v216
    v_fmac_f32 v153, v145, v216
    v_mfma_f32_16x16x32_bf16 v[180:183], v[32:35], v[204:207], 0
    ds_read_b128 v[196:199], v17 offset:6400
    v_fmac_f32 v154, v146, v216
    s_waitcnt lgkmcnt(4)
    v_mfma_f32_16x16x32_bf16 v[168:171], v[36:39], v[208:211], v[168:171]
    v_fmac_f32 v155, v147, v216
    v_fmac_f32 v156, v144, v217
    v_mfma_f32_16x16x32_bf16 v[176:179], v[40:43], v[208:211], v[176:179]
    ds_read_b128 v[200:203], v17 offset:8192
    v_fmac_f32 v157, v145, v217
    v_mfma_f32_16x16x32_bf16 v[172:175], v[36:39], v[212:215], v[172:175]
    v_fmac_f32 v158, v146, v217
    v_fmac_f32 v159, v147, v217
    v_mfma_f32_16x16x32_bf16 v[180:183], v[40:43], v[212:215], v[180:183]
    ds_read_b128 v[204:207], v17 offset:8448
    v_fmac_f32 v160, v148, v216
    s_waitcnt lgkmcnt(4)
    v_mfma_f32_16x16x32_bf16 v[168:171], v[44:47], v[184:187], v[168:171]
    v_max_f32 v152, 0, v152
    v_fmac_f32 v161, v149, v216
    v_mfma_f32_16x16x32_bf16 v[176:179], v[48:51], v[184:187], v[176:179]
    ds_read_b128 v[208:211], v17 offset:10240
    v_max_f32 v153, 0, v153
    v_mfma_f32_16x16x32_bf16 v[172:175], v[44:47], v[188:191], v[172:175]
    v_fmac_f32 v162, v150, v216
    v_max_f32 v154, 0, v154
    v_mfma_f32_16x16x32_bf16 v[180:183], v[48:51], v[188:191], v[180:183]
    ds_read_b128 v[212:215], v17 offset:10496
    v_fmac_f32 v163, v151, v216
    s_waitcnt lgkmcnt(4)
    v_mfma_f32_16x16x32_bf16 v[168:171], v[52:55], v[192:195], v[168:171]
    v_max_f32 v155, 0, v155
    v_fmac_f32 v164, v148, v217
    v_mfma_f32_16x16x32_bf16 v[176:179], v[56:59], v[192:195], v[176:179]
    ds_read_b128 v[184:187], v17 offset:12288
    v_max_f32 v156, 0, v156
    v_mfma_f32_16x16x32_bf16 v[172:175], v[52:55], v[196:199], v[172:175]
    v_fmac_f32 v165, v149, v217
    v_max_f32 v157, 0, v157
    v_mfma_f32_16x16x32_bf16 v[180:183], v[56:59], v[196:199], v[180:183]
    ds_read_b128 v[188:191], v17 offset:12544
    v_fmac_f32 v166, v150, v217
    s_waitcnt lgkmcnt(4)
    v_mfma_f32_16x16x32_bf16 v[168:171], v[60:63], v[200:203], v[168:171]
    v_max_f32 v158, 0, v158
    v_fmac_f32 v167, v151, v217
    v_mfma_f32_16x16x32_bf16 v[176:179], v[64:67], v[200:203], v[176:179]
    ds_read_b128 v[192:195], v17 offset:14336
    v_max_f32 v159, 0, v159
    v_mfma_f32_16x16x32_bf16 v[172:175], v[60:63], v[204:207], v[172:175]
    v_mul_f32 v152, v152, v160
    v_mul_f32 v153, v153, v161
    v_mfma_f32_16x16x32_bf16 v[180:183], v[64:67], v[204:207], v[180:183]
    ds_read_b128 v[196:199], v17 offset:14592
    v_mul_f32 v154, v154, v162
    s_waitcnt lgkmcnt(4)
    v_mfma_f32_16x16x32_bf16 v[168:171], v[68:71], v[208:211], v[168:171]
    v_mul_f32 v155, v155, v163
    v_mul_f32 v156, v156, v164
    v_mfma_f32_16x16x32_bf16 v[176:179], v[72:75], v[208:211], v[176:179]
    ds_read_b128 v[200:203], v17 offset:16384
    v_mul_f32 v157, v157, v165
    v_mfma_f32_16x16x32_bf16 v[172:175], v[68:71], v[212:215], v[172:175]
    v_mul_f32 v158, v158, v166
    v_mul_f32 v159, v159, v167
    v_mfma_f32_16x16x32_bf16 v[180:183], v[72:75], v[212:215], v[180:183]
    ds_read_b128 v[204:207], v17 offset:16640
    v_cvt_pk_bf16_f32 v220, v152, v153
    s_waitcnt lgkmcnt(4)
    v_mfma_f32_16x16x32_bf16 v[168:171], v[76:79], v[184:187], v[168:171]
    v_cvt_pk_bf16_f32 v222, v156, v157
    v_cvt_pk_bf16_f32 v221, v154, v155
    v_mfma_f32_16x16x32_bf16 v[176:179], v[80:83], v[184:187], v[176:179]
    ds_read_b128 v[208:211], v17 offset:18432
    v_cvt_pk_bf16_f32 v223, v158, v159
    v_mfma_f32_16x16x32_bf16 v[172:175], v[76:79], v[188:191], v[172:175]
    v_permlane16_swap_b32 v220, v222
    v_permlane16_swap_b32 v221, v223
    v_mfma_f32_16x16x32_bf16 v[180:183], v[80:83], v[188:191], v[180:183]
    ds_read_b128 v[212:215], v17 offset:18688
    buffer_store_dwordx4 v[220:223], v2, s[36:39], s55 offen sc1
    s_waitcnt lgkmcnt(4)
    v_mfma_f32_16x16x32_bf16 v[168:171], v[84:87], v[192:195], v[168:171]
    v_add_u32 v16, s68, v18
    s_add_u32 s68, s68, 28672
    v_mfma_f32_16x16x32_bf16 v[176:179], v[88:91], v[192:195], v[176:179]
    ds_read_b128 v[184:187], v17 offset:20480
    s_cmp_eq_u32 s68, 118784
    s_cselect_b32 s68, 32768, s68
    v_mfma_f32_16x16x32_bf16 v[172:175], v[84:87], v[196:199], v[172:175]
    v_mfma_f32_16x16x32_bf16 v[180:183], v[88:91], v[196:199], v[180:183]
    ds_read_b128 v[188:191], v17 offset:20736
    s_waitcnt lgkmcnt(4)
    v_mfma_f32_16x16x32_bf16 v[168:171], v[92:95], v[200:203], v[168:171]
    v_mfma_f32_16x16x32_bf16 v[176:179], v[96:99], v[200:203], v[176:179]
    ds_read_b128 v[192:195], v17 offset:22528
    v_mfma_f32_16x16x32_bf16 v[172:175], v[92:95], v[204:207], v[172:175]
    v_mfma_f32_16x16x32_bf16 v[180:183], v[96:99], v[204:207], v[180:183]
    ds_read_b128 v[196:199], v17 offset:22784
    s_waitcnt lgkmcnt(4)
    v_mfma_f32_16x16x32_bf16 v[168:171], v[100:103], v[208:211], v[168:171]
    v_mfma_f32_16x16x32_bf16 v[176:179], v[104:107], v[208:211], v[176:179]
    ds_read_b128 v[200:203], v17 offset:24576
    v_mfma_f32_16x16x32_bf16 v[172:175], v[100:103], v[212:215], v[172:175]
    v_mfma_f32_16x16x32_bf16 v[180:183], v[104:107], v[212:215], v[180:183]
    ds_read_b128 v[204:207], v17 offset:24832
    s_waitcnt lgkmcnt(4)
    v_mfma_f32_16x16x32_bf16 v[168:171], v[108:111], v[184:187], v[168:171]
    v_mfma_f32_16x16x32_bf16 v[176:179], v[112:115], v[184:187], v[176:179]
    ds_read_b128 v[208:211], v17 offset:26624
    v_mfma_f32_16x16x32_bf16 v[172:175], v[108:111], v[188:191], v[172:175]
    v_mfma_f32_16x16x32_bf16 v[180:183], v[112:115], v[188:191], v[180:183]
    ds_read_b128 v[212:215], v17 offset:26880
    s_waitcnt lgkmcnt(5)
    v_mfma_f32_16x16x32_bf16 v[168:171], v[116:119], v[192:195], v[168:171]
    v_mfma_f32_16x16x32_bf16 v[176:179], v[120:123], v[192:195], v[176:179]
    s_waitcnt lgkmcnt(4)
    v_mfma_f32_16x16x32_bf16 v[172:175], v[116:119], v[196:199], v[172:175]
    v_mfma_f32_16x16x32_bf16 v[180:183], v[120:123], v[196:199], v[180:183]
    s_waitcnt lgkmcnt(3)
    v_mfma_f32_16x16x32_bf16 v[168:171], v[124:127], v[200:203], v[168:171]
    v_mfma_f32_16x16x32_bf16 v[176:179], v[128:131], v[200:203], v[176:179]
    s_waitcnt vmcnt(1) lgkmcnt(0)
    s_barrier
    ds_read2_b32 v[216:217], v12 offset0:0 offset1:16
    v_add_u32 v12, 0x80, v12
    v_mfma_f32_16x16x32_bf16 v[172:175], v[124:127], v[204:207], v[172:175]
    v_mfma_f32_16x16x32_bf16 v[180:183], v[128:131], v[204:207], v[180:183]
    ds_read_b128 v[184:187], v16 offset:0
    ds_read_b128 v[188:191], v16 offset:256
    v_mfma_f32_16x16x32_bf16 v[168:171], v[132:135], v[208:211], v[168:171]
    v_mfma_f32_16x16x32_bf16 v[176:179], v[136:139], v[208:211], v[176:179]
    ds_read_b128 v[192:195], v16 offset:2048
    ds_read_b128 v[196:199], v16 offset:2304
    v_mfma_f32_16x16x32_bf16 v[172:175], v[132:135], v[212:215], v[172:175]
    v_mfma_f32_16x16x32_bf16 v[180:183], v[136:139], v[212:215], v[180:183]
    ds_read_b128 v[200:203], v16 offset:4096
    ds_read_b128 v[204:207], v16 offset:4352
    s_waitcnt lgkmcnt(4)
    v_mfma_f32_16x16x32_bf16 v[152:155], v[28:31], v[184:187], 0
    s_add_u32 s55, s58, s57
    s_add_u32 s57, s57, 114688
    v_mfma_f32_16x16x32_bf16 v[160:163], v[32:35], v[184:187], 0
    ds_read_b128 v[208:211], v16 offset:6144
    s_cmp_eq_u32 s57, 917504
    s_cselect_b32 s57, 0, s57
    v_mfma_f32_16x16x32_bf16 v[156:159], v[28:31], v[188:191], 0
    v_fmac_f32 v168, v144, v216
    v_fmac_f32 v169, v145, v216
    v_mfma_f32_16x16x32_bf16 v[164:167], v[32:35], v[188:191], 0
    ds_read_b128 v[212:215], v16 offset:6400
    v_fmac_f32 v170, v146, v216
    s_waitcnt lgkmcnt(4)
    v_mfma_f32_16x16x32_bf16 v[152:155], v[36:39], v[192:195], v[152:155]
    v_fmac_f32 v171, v147, v216
    v_fmac_f32 v172, v144, v217
    v_mfma_f32_16x16x32_bf16 v[160:163], v[40:43], v[192:195], v[160:163]
    ds_read_b128 v[184:187], v16 offset:8192
    v_fmac_f32 v173, v145, v217
    v_mfma_f32_16x16x32_bf16 v[156:159], v[36:39], v[196:199], v[156:159]
    v_fmac_f32 v174, v146, v217
    v_fmac_f32 v175, v147, v217
    v_mfma_f32_16x16x32_bf16 v[164:167], v[40:43], v[196:199], v[164:167]
    ds_read_b128 v[188:191], v16 offset:8448
    v_fmac_f32 v176, v148, v216
    s_waitcnt lgkmcnt(4)
    v_mfma_f32_16x16x32_bf16 v[152:155], v[44:47], v[200:203], v[152:155]
    v_max_f32 v168, 0, v168
    v_fmac_f32 v177, v149, v216
    v_mfma_f32_16x16x32_bf16 v[160:163], v[48:51], v[200:203], v[160:163]
    ds_read_b128 v[192:195], v16 offset:10240
    v_max_f32 v169, 0, v169
    v_mfma_f32_16x16x32_bf16 v[156:159], v[44:47], v[204:207], v[156:159]
    v_fmac_f32 v178, v150, v216
    v_max_f32 v170, 0, v170
    v_mfma_f32_16x16x32_bf16 v[164:167], v[48:51], v[204:207], v[164:167]
    ds_read_b128 v[196:199], v16 offset:10496
    v_fmac_f32 v179, v151, v216
    s_waitcnt lgkmcnt(4)
    v_mfma_f32_16x16x32_bf16 v[152:155], v[52:55], v[208:211], v[152:155]
    v_max_f32 v171, 0, v171
    v_fmac_f32 v180, v148, v217
    v_mfma_f32_16x16x32_bf16 v[160:163], v[56:59], v[208:211], v[160:163]
    ds_read_b128 v[200:203], v16 offset:12288
    v_max_f32 v172, 0, v172
    v_mfma_f32_16x16x32_bf16 v[156:159], v[52:55], v[212:215], v[156:159]
    v_fmac_f32 v181, v149, v217
    v_max_f32 v173, 0, v173
    v_mfma_f32_16x16x32_bf16 v[164:167], v[56:59], v[212:215], v[164:167]
    ds_read_b128 v[204:207], v16 offset:12544
    v_fmac_f32 v182, v150, v217
    s_waitcnt lgkmcnt(4)
    v_mfma_f32_16x16x32_bf16 v[152:155], v[60:63], v[184:187], v[152:155]
    v_max_f32 v174, 0, v174
    v_fmac_f32 v183, v151, v217
    v_mfma_f32_16x16x32_bf16 v[160:163], v[64:67], v[184:187], v[160:163]
    ds_read_b128 v[208:211], v16 offset:14336
    v_max_f32 v175, 0, v175
    v_mfma_f32_16x16x32_bf16 v[156:159], v[60:63], v[188:191], v[156:159]
    v_mul_f32 v168, v168, v176
    v_mul_f32 v169, v169, v177
    v_mfma_f32_16x16x32_bf16 v[164:167], v[64:67], v[188:191], v[164:167]
    ds_read_b128 v[212:215], v16 offset:14592
    v_mul_f32 v170, v170, v178
    s_waitcnt lgkmcnt(4)
    v_mfma_f32_16x16x32_bf16 v[152:155], v[68:71], v[192:195], v[152:155]
    v_mul_f32 v171, v171, v179
    v_mul_f32 v172, v172, v180
    v_mfma_f32_16x16x32_bf16 v[160:163], v[72:75], v[192:195], v[160:163]
    ds_read_b128 v[184:187], v16 offset:16384
    v_mul_f32 v173, v173, v181
    v_mfma_f32_16x16x32_bf16 v[156:159], v[68:71], v[196:199], v[156:159]
    v_mul_f32 v174, v174, v182
    v_mul_f32 v175, v175, v183
    v_mfma_f32_16x16x32_bf16 v[164:167], v[72:75], v[196:199], v[164:167]
    ds_read_b128 v[188:191], v16 offset:16640
    v_cvt_pk_bf16_f32 v220, v168, v169
    s_waitcnt lgkmcnt(4)
    v_mfma_f32_16x16x32_bf16 v[152:155], v[76:79], v[200:203], v[152:155]
    v_cvt_pk_bf16_f32 v222, v172, v173
    v_cvt_pk_bf16_f32 v221, v170, v171
    v_mfma_f32_16x16x32_bf16 v[160:163], v[80:83], v[200:203], v[160:163]
    ds_read_b128 v[192:195], v16 offset:18432
    v_cvt_pk_bf16_f32 v223, v174, v175
    v_mfma_f32_16x16x32_bf16 v[156:159], v[76:79], v[204:207], v[156:159]
    v_permlane16_swap_b32 v220, v222
    v_permlane16_swap_b32 v221, v223
    v_mfma_f32_16x16x32_bf16 v[164:167], v[80:83], v[204:207], v[164:167]
    ds_read_b128 v[196:199], v16 offset:18688
    buffer_store_dwordx4 v[220:223], v2, s[36:39], s55 offen sc1
    s_waitcnt lgkmcnt(4)
    v_mfma_f32_16x16x32_bf16 v[152:155], v[84:87], v[208:211], v[152:155]
    v_add_u32 v17, s68, v18
    s_add_u32 s68, s68, 28672
    v_mfma_f32_16x16x32_bf16 v[160:163], v[88:91], v[208:211], v[160:163]
    ds_read_b128 v[200:203], v16 offset:20480
    s_cmp_eq_u32 s68, 118784
    s_cselect_b32 s68, 32768, s68
    v_mfma_f32_16x16x32_bf16 v[156:159], v[84:87], v[212:215], v[156:159]
    v_mfma_f32_16x16x32_bf16 v[164:167], v[88:91], v[212:215], v[164:167]
    ds_read_b128 v[204:207], v16 offset:20736
    s_waitcnt lgkmcnt(4)
    v_mfma_f32_16x16x32_bf16 v[152:155], v[92:95], v[184:187], v[152:155]
    v_mfma_f32_16x16x32_bf16 v[160:163], v[96:99], v[184:187], v[160:163]
    ds_read_b128 v[208:211], v16 offset:22528
    v_mfma_f32_16x16x32_bf16 v[156:159], v[92:95], v[188:191], v[156:159]
    v_mfma_f32_16x16x32_bf16 v[164:167], v[96:99], v[188:191], v[164:167]
    ds_read_b128 v[212:215], v16 offset:22784
    s_waitcnt lgkmcnt(4)
    v_mfma_f32_16x16x32_bf16 v[152:155], v[100:103], v[192:195], v[152:155]
    v_mfma_f32_16x16x32_bf16 v[160:163], v[104:107], v[192:195], v[160:163]
    ds_read_b128 v[184:187], v16 offset:24576
    v_mfma_f32_16x16x32_bf16 v[156:159], v[100:103], v[196:199], v[156:159]
    v_mfma_f32_16x16x32_bf16 v[164:167], v[104:107], v[196:199], v[164:167]
    ds_read_b128 v[188:191], v16 offset:24832
    s_waitcnt lgkmcnt(4)
    v_mfma_f32_16x16x32_bf16 v[152:155], v[108:111], v[200:203], v[152:155]
    v_mfma_f32_16x16x32_bf16 v[160:163], v[112:115], v[200:203], v[160:163]
    ds_read_b128 v[192:195], v16 offset:26624
    v_mfma_f32_16x16x32_bf16 v[156:159], v[108:111], v[204:207], v[156:159]
    v_mfma_f32_16x16x32_bf16 v[164:167], v[112:115], v[204:207], v[164:167]
    ds_read_b128 v[196:199], v16 offset:26880
    s_waitcnt lgkmcnt(5)
    v_mfma_f32_16x16x32_bf16 v[152:155], v[116:119], v[208:211], v[152:155]
    v_mfma_f32_16x16x32_bf16 v[160:163], v[120:123], v[208:211], v[160:163]
    s_waitcnt lgkmcnt(4)
    v_mfma_f32_16x16x32_bf16 v[156:159], v[116:119], v[212:215], v[156:159]
    v_mfma_f32_16x16x32_bf16 v[164:167], v[120:123], v[212:215], v[164:167]
    s_waitcnt lgkmcnt(3)
    v_mfma_f32_16x16x32_bf16 v[152:155], v[124:127], v[184:187], v[152:155]
    v_mfma_f32_16x16x32_bf16 v[160:163], v[128:131], v[184:187], v[160:163]
    s_waitcnt lgkmcnt(0)
    s_barrier
    ds_read2_b32 v[216:217], v12 offset0:0 offset1:16
    v_add_u32 v12, 0x80, v12
    v_mfma_f32_16x16x32_bf16 v[156:159], v[124:127], v[188:191], v[156:159]
    v_mfma_f32_16x16x32_bf16 v[164:167], v[128:131], v[188:191], v[164:167]
    ds_read_b128 v[200:203], v17 offset:0
    ds_read_b128 v[204:207], v17 offset:256
    v_mfma_f32_16x16x32_bf16 v[152:155], v[132:135], v[192:195], v[152:155]
    v_mfma_f32_16x16x32_bf16 v[160:163], v[136:139], v[192:195], v[160:163]
    ds_read_b128 v[208:211], v17 offset:2048
    ds_read_b128 v[212:215], v17 offset:2304
    v_mfma_f32_16x16x32_bf16 v[156:159], v[132:135], v[196:199], v[156:159]
    v_mfma_f32_16x16x32_bf16 v[164:167], v[136:139], v[196:199], v[164:167]
    ds_read_b128 v[184:187], v17 offset:4096
    ds_read_b128 v[188:191], v17 offset:4352
    s_sub_u32 s67, s67, 1
    s_cbranch_scc0 P3LOOP
    s_waitcnt lgkmcnt(4)
    v_mfma_f32_16x16x32_bf16 v[168:171], v[28:31], v[200:203], 0
    s_add_u32 s55, s58, s57
    s_add_u32 s57, s57, 114688
    v_mfma_f32_16x16x32_bf16 v[176:179], v[32:35], v[200:203], 0
    ds_read_b128 v[192:195], v17 offset:6144
    s_cmp_eq_u32 s57, 917504
    s_cselect_b32 s57, 0, s57
    v_mfma_f32_16x16x32_bf16 v[172:175], v[28:31], v[204:207], 0
    v_fmac_f32 v152, v144, v216
    v_fmac_f32 v153, v145, v216
    v_mfma_f32_16x16x32_bf16 v[180:183], v[32:35], v[204:207], 0
    ds_read_b128 v[196:199], v17 offset:6400
    v_fmac_f32 v154, v146, v216
    s_waitcnt lgkmcnt(4)
    v_mfma_f32_16x16x32_bf16 v[168:171], v[36:39], v[208:211], v[168:171]
    v_fmac_f32 v155, v147, v216
    v_fmac_f32 v156, v144, v217
    v_mfma_f32_16x16x32_bf16 v[176:179], v[40:43], v[208:211], v[176:179]
    ds_read_b128 v[200:203], v17 offset:8192
    v_fmac_f32 v157, v145, v217
    v_mfma_f32_16x16x32_bf16 v[172:175], v[36:39], v[212:215], v[172:175]
    v_fmac_f32 v158, v146, v217
    v_fmac_f32 v159, v147, v217
    v_mfma_f32_16x16x32_bf16 v[180:183], v[40:43], v[212:215], v[180:183]
    ds_read_b128 v[204:207], v17 offset:8448
    v_fmac_f32 v160, v148, v216
    s_waitcnt lgkmcnt(4)
    v_mfma_f32_16x16x32_bf16 v[168:171], v[44:47], v[184:187], v[168:171]
    v_max_f32 v152, 0, v152
    v_fmac_f32 v161, v149, v216
    v_mfma_f32_16x16x32_bf16 v[176:179], v[48:51], v[184:187], v[176:179]
    ds_read_b128 v[208:211], v17 offset:10240
    v_max_f32 v153, 0, v153
    v_mfma_f32_16x16x32_bf16 v[172:175], v[44:47], v[188:191], v[172:175]
    v_fmac_f32 v162, v150, v216
    v_max_f32 v154, 0, v154
    v_mfma_f32_16x16x32_bf16 v[180:183], v[48:51], v[188:191], v[180:183]
    ds_read_b128 v[212:215], v17 offset:10496
    v_fmac_f32 v163, v151, v216
    s_waitcnt lgkmcnt(4)
    v_mfma_f32_16x16x32_bf16 v[168:171], v[52:55], v[192:195], v[168:171]
    v_max_f32 v155, 0, v155
    v_fmac_f32 v164, v148, v217
    v_mfma_f32_16x16x32_bf16 v[176:179], v[56:59], v[192:195], v[176:179]
    ds_read_b128 v[184:187], v17 offset:12288
    v_max_f32 v156, 0, v156
    v_mfma_f32_16x16x32_bf16 v[172:175], v[52:55], v[196:199], v[172:175]
    v_fmac_f32 v165, v149, v217
    v_max_f32 v157, 0, v157
    v_mfma_f32_16x16x32_bf16 v[180:183], v[56:59], v[196:199], v[180:183]
    ds_read_b128 v[188:191], v17 offset:12544
    v_fmac_f32 v166, v150, v217
    s_waitcnt lgkmcnt(4)
    v_mfma_f32_16x16x32_bf16 v[168:171], v[60:63], v[200:203], v[168:171]
    v_max_f32 v158, 0, v158
    v_fmac_f32 v167, v151, v217
    v_mfma_f32_16x16x32_bf16 v[176:179], v[64:67], v[200:203], v[176:179]
    ds_read_b128 v[192:195], v17 offset:14336
    v_max_f32 v159, 0, v159
    v_mfma_f32_16x16x32_bf16 v[172:175], v[60:63], v[204:207], v[172:175]
    v_mul_f32 v152, v152, v160
    v_mul_f32 v153, v153, v161
    v_mfma_f32_16x16x32_bf16 v[180:183], v[64:67], v[204:207], v[180:183]
    ds_read_b128 v[196:199], v17 offset:14592
    v_mul_f32 v154, v154, v162
    s_waitcnt lgkmcnt(4)
    v_mfma_f32_16x16x32_bf16 v[168:171], v[68:71], v[208:211], v[168:171]
    v_mul_f32 v155, v155, v163
    v_mul_f32 v156, v156, v164
    v_mfma_f32_16x16x32_bf16 v[176:179], v[72:75], v[208:211], v[176:179]
    ds_read_b128 v[200:203], v17 offset:16384
    v_mul_f32 v157, v157, v165
    v_mfma_f32_16x16x32_bf16 v[172:175], v[68:71], v[212:215], v[172:175]
    v_mul_f32 v158, v158, v166
    v_mul_f32 v159, v159, v167
    v_mfma_f32_16x16x32_bf16 v[180:183], v[72:75], v[212:215], v[180:183]
    ds_read_b128 v[204:207], v17 offset:16640
    v_cvt_pk_bf16_f32 v220, v152, v153
    s_waitcnt lgkmcnt(4)
    v_mfma_f32_16x16x32_bf16 v[168:171], v[76:79], v[184:187], v[168:171]
    v_cvt_pk_bf16_f32 v222, v156, v157
    v_cvt_pk_bf16_f32 v221, v154, v155
    v_mfma_f32_16x16x32_bf16 v[176:179], v[80:83], v[184:187], v[176:179]
    ds_read_b128 v[208:211], v17 offset:18432
    v_cvt_pk_bf16_f32 v223, v158, v159
    s_waitcnt vmcnt(0)
    s_mov_b64 exec, 1
    buffer_atomic_add v229, v25, s[36:39], s75 offen sc1
    s_mov_b64 exec, -1
    v_mfma_f32_16x16x32_bf16 v[172:175], v[76:79], v[188:191], v[172:175]
    v_permlane16_swap_b32 v220, v222
    v_permlane16_swap_b32 v221, v223
    v_mfma_f32_16x16x32_bf16 v[180:183], v[80:83], v[188:191], v[180:183]
    ds_read_b128 v[212:215], v17 offset:18688
    buffer_store_dwordx4 v[220:223], v2, s[36:39], s55 offen sc1
    s_waitcnt lgkmcnt(4)
    v_mfma_f32_16x16x32_bf16 v[168:171], v[84:87], v[192:195], v[168:171]
    v_mfma_f32_16x16x32_bf16 v[176:179], v[88:91], v[192:195], v[176:179]
    ds_read_b128 v[184:187], v17 offset:20480
    v_mfma_f32_16x16x32_bf16 v[172:175], v[84:87], v[196:199], v[172:175]
    v_mfma_f32_16x16x32_bf16 v[180:183], v[88:91], v[196:199], v[180:183]
    ds_read_b128 v[188:191], v17 offset:20736
    s_waitcnt lgkmcnt(4)
    v_mfma_f32_16x16x32_bf16 v[168:171], v[92:95], v[200:203], v[168:171]
    v_mfma_f32_16x16x32_bf16 v[176:179], v[96:99], v[200:203], v[176:179]
    ds_read_b128 v[192:195], v17 offset:22528
    v_mfma_f32_16x16x32_bf16 v[172:175], v[92:95], v[204:207], v[172:175]
    v_mfma_f32_16x16x32_bf16 v[180:183], v[96:99], v[204:207], v[180:183]
    ds_read_b128 v[196:199], v17 offset:22784
    s_waitcnt lgkmcnt(4)
    v_mfma_f32_16x16x32_bf16 v[168:171], v[100:103], v[208:211], v[168:171]
    v_mfma_f32_16x16x32_bf16 v[176:179], v[104:107], v[208:211], v[176:179]
    ds_read_b128 v[200:203], v17 offset:24576
    v_mfma_f32_16x16x32_bf16 v[172:175], v[100:103], v[212:215], v[172:175]
    v_mfma_f32_16x16x32_bf16 v[180:183], v[104:107], v[212:215], v[180:183]
    ds_read_b128 v[204:207], v17 offset:24832
    s_waitcnt lgkmcnt(4)
    v_mfma_f32_16x16x32_bf16 v[168:171], v[108:111], v[184:187], v[168:171]
    v_mfma_f32_16x16x32_bf16 v[176:179], v[112:115], v[184:187], v[176:179]
    ds_read_b128 v[208:211], v17 offset:26624
    v_mfma_f32_16x16x32_bf16 v[172:175], v[108:111], v[188:191], v[172:175]
    v_mfma_f32_16x16x32_bf16 v[180:183], v[112:115], v[188:191], v[180:183]
    ds_read_b128 v[212:215], v17 offset:26880
    s_waitcnt lgkmcnt(5)
    v_mfma_f32_16x16x32_bf16 v[168:171], v[116:119], v[192:195], v[168:171]
    v_mfma_f32_16x16x32_bf16 v[176:179], v[120:123], v[192:195], v[176:179]
    s_mov_b64 exec, s[70:71]
    buffer_load_dword v224, v7, s[36:39], s65 offen sc1
    s_mov_b64 exec, -1
    s_waitcnt lgkmcnt(4)
    v_mfma_f32_16x16x32_bf16 v[172:175], v[116:119], v[196:199], v[172:175]
    v_mfma_f32_16x16x32_bf16 v[180:183], v[120:123], v[196:199], v[180:183]
    s_waitcnt lgkmcnt(3)
    v_mfma_f32_16x16x32_bf16 v[168:171], v[124:127], v[200:203], v[168:171]
    v_mfma_f32_16x16x32_bf16 v[176:179], v[128:131], v[200:203], v[176:179]
    s_waitcnt lgkmcnt(0)
    s_barrier
    ds_read2_b32 v[216:217], v12 offset0:0 offset1:16
    v_add_u32 v12, 0x80, v12
    v_mfma_f32_16x16x32_bf16 v[172:175], v[124:127], v[204:207], v[172:175]
    v_mfma_f32_16x16x32_bf16 v[180:183], v[128:131], v[204:207], v[180:183]
    v_mfma_f32_16x16x32_bf16 v[168:171], v[132:135], v[208:211], v[168:171]
    v_mfma_f32_16x16x32_bf16 v[176:179], v[136:139], v[208:211], v[176:179]
    v_mfma_f32_16x16x32_bf16 v[172:175], v[132:135], v[212:215], v[172:175]
    v_mfma_f32_16x16x32_bf16 v[180:183], v[136:139], v[212:215], v[180:183]
    s_setprio 2
    v_mov_b32 v232, 4
    v_mov_b32 v233, 162192
    s_lshl_b32 s59, s44, 2
    s_mov_b32 s66, 320000
    s_mov_b32 s67, 0
    s_add_u32 s55, s58, s57
    s_add_u32 s57, s57, 114688
    s_cmp_eq_u32 s57, 917504
    s_cselect_b32 s57, 0, s57
    s_waitcnt lgkmcnt(0)
    v_fmac_f32 v168, v144, v216
    v_fmac_f32 v169, v145, v216
    v_fmac_f32 v170, v146, v216
    v_fmac_f32 v171, v147, v216
    v_fmac_f32 v172, v144, v217
    v_fmac_f32 v173, v145, v217
    v_fmac_f32 v174, v146, v217
    v_fmac_f32 v175, v147, v217
    v_fmac_f32 v176, v148, v216
    v_max_f32 v168, 0, v168
    v_fmac_f32 v177, v149, v216
    v_max_f32 v169, 0, v169
    v_fmac_f32 v178, v150, v216
    v_max_f32 v170, 0, v170
    v_fmac_f32 v179, v151, v216
    v_max_f32 v171, 0, v171
    v_fmac_f32 v180, v148, v217
    v_max_f32 v172, 0, v172
    v_fmac_f32 v181, v149, v217
    v_max_f32 v173, 0, v173
    v_fmac_f32 v182, v150, v217
    v_max_f32 v174, 0, v174
    v_fmac_f32 v183, v151, v217
    v_max_f32 v175, 0, v175
    v_mul_f32 v168, v168, v176
    v_mul_f32 v169, v169, v177
    v_mul_f32 v170, v170, v178
    v_mul_f32 v171, v171, v179
    v_mul_f32 v172, v172, v180
    v_mul_f32 v173, v173, v181
    v_mul_f32 v174, v174, v182
    v_mul_f32 v175, v175, v183
    v_cvt_pk_bf16_f32 v220, v168, v169
    v_cvt_pk_bf16_f32 v222, v172, v173
    v_cvt_pk_bf16_f32 v221, v170, v171
    v_cvt_pk_bf16_f32 v223, v174, v175
    v_permlane16_swap_b32 v220, v222
    s_nop 0
    v_permlane16_swap_b32 v221, v223
    buffer_store_dwordx4 v[220:223], v2, s[36:39], s55 offen sc1
    s_setprio 3
    s_mov_b64 exec, s[70:71]
    s_waitcnt vmcnt(1)
    v_cmp_eq_u32 s[68:69], s47, v224
    s_mov_b64 exec, -1
    s_andn2_b64 s[72:73], s[70:71], s[68:69]
    s_cbranch_scc1 XLATE
    s_add_u32 m0, s64, 81920
    s_add_u32 s3, s60, 12288
    buffer_load_dwordx4 v2, s[36:39], s3 offen  sc1 lds
    buffer_load_dwordx4 v2, s[36:39], s3 offen offset:1024 sc1 lds
    s_sub_u32 s3, s61, 2048
    buffer_load_dwordx4 v2, s[36:39], s3 offen offset:2048 sc1 lds
    buffer_load_dwordx4 v2, s[36:39], s3 offen offset:3072 sc1 lds
    s_add_u32 m0, s59, 162736
    s_mov_b64 exec, 1
    buffer_load_dword v232, s[40:43], 0 offen sc1 lds
    s_mov_b64 exec, -1
    s_add_u32 m0, s64, 98304
    s_add_u32 s3, s61, 2048
    buffer_load_dwordx4 v2, s[36:39], s3 offen  sc1 lds
    buffer_load_dwordx4 v2, s[36:39], s3 offen offset:1024 sc1 lds
    buffer_load_dwordx4 v2, s[36:39], s3 offen offset:2048 sc1 lds
    buffer_load_dwordx4 v2, s[36:39], s3 offen offset:3072 sc1 lds
    s_add_u32 m0, s59, 162752
    s_mov_b64 exec, 1
    buffer_load_dword v232, s[40:43], 0 offen sc1 lds
    s_mov_b64 exec, -1
XLATE:
    s_cmp_lt_u32 s44, 2
    s_cbranch_scc1 XNE
    s_and_b32 s3, s44, 1
    s_add_u32 s3, s3, s54
    s_lshl_b32 s3, s3, 15
    s_add_u32 s3, s3, 2125824
    v_mov_b32 v32, 0
    v_mov_b32 v33, 0
    v_mov_b32 v34, 0
    v_mov_b32 v35, 0
    buffer_load_dwordx4 v[28:31], v2, s[36:39], s3 offen offset:0 sc1
    s_mov_b32 exec_hi, 0xffff
    buffer_load_dwordx4 v[32:35], v2, s[36:39], s3 offen offset:1024 sc1
    s_mov_b64 exec, -1
    v_mov_b32 v40, 0
    v_mov_b32 v41, 0
    v_mov_b32 v42, 0
    v_mov_b32 v43, 0
    buffer_load_dwordx4 v[36:39], v2, s[36:39], s3 offen offset:1792 sc1
    s_mov_b32 exec_hi, 0xffff
    buffer_load_dwordx4 v[40:43], v2, s[36:39], s3 offen offset:2816 sc1
    s_mov_b64 exec, -1
    s_lshl_b32 s4, s53, 12
    s_add_u32 s3, s3, s4
    s_sub_u32 s3, s3, 28672
    s_and_b32 s57, s44, 1
    s_mul_i32 s4, s57, 41984
    s_add_u32 m0, s4, 114688
    s_nop 0
    buffer_load_dwordx4 v2, s[36:39], s3 offen  sc1 lds
    buffer_load_dwordx4 v2, s[36:39], s3 offen offset:1024 sc1 lds
    buffer_load_dwordx4 v2, s[36:39], s3 offen offset:2048 sc1 lds
    buffer_load_dwordx4 v2, s[36:39], s3 offen offset:3072 sc1 lds
    s_waitcnt vmcnt(18)
    s_cmp_eq_u64 s[72:73], 0
    s_cbranch_scc1 XCNT
    s_waitcnt vmcnt(8)
    s_branch XCNT
XNE:
    s_cmp_ge_u32 s67, 3
    s_cbranch_scc1 SWD_71
SW_70:
    ds_read_b128 v[228:231], v233
    s_sub_u32 s66, s66, 1
    s_cbranch_scc1 END_X
    s_waitcnt lgkmcnt(0)
    v_min3_u32 v228, v228, v229, v230
    v_min_u32 v228, v228, v231
    s_nop 0
    v_readfirstlane_b32 s67, v228
    s_nop 0
    s_cmp_ge_u32 s67, 3
    s_cbranch_scc1 SWD_71
    s_sleep 1
    s_branch SW_70
SWD_71:
    s_waitcnt vmcnt(10)
    s_cmp_eq_u64 s[72:73], 0
    s_cbranch_scc1 XCNT
    s_waitcnt vmcnt(0)
XCNT:
    s_atomic_add s0, s[36:37], s56
    s_branch PG_72
.p2align 12
STUB_x4:
    s_setpc_b64 s[6:7]
    s_nop 0
PG_72:
    s_cmp_eq_u64 s[72:73], 0
    s_cbranch_scc1 XSPEC
    s_mov_b64 exec, s[70:71]
    s_mov_b32 s5, 0
POLL_73:
    buffer_load_dword v224, v7, s[36:39], s65 offen sc1
    s_waitcnt vmcnt(0)
    v_cmp_eq_u32 s[76:77], s47, v224
    s_add_u32 s5, s5, 1
    s_cmp_gt_u32 s5, 40000
    s_cbranch_scc1 POLLD_74
    s_andn2_b64 s[6:7], s[70:71], s[76:77]
    s_cbranch_scc1 POLL_73
POLLD_74:
    s_mov_b64 exec, -1
    s_add_u32 m0, s64, 81920
    s_add_u32 s3, s60, 12288
    buffer_load_dwordx4 v2, s[36:39], s3 offen  sc1 lds
    buffer_load_dwordx4 v2, s[36:39], s3 offen offset:1024 sc1 lds
    s_sub_u32 s3, s61, 2048
    buffer_load_dwordx4 v2, s[36:39], s3 offen offset:2048 sc1 lds
    buffer_load_dwordx4 v2, s[36:39], s3 offen offset:3072 sc1 lds
    s_add_u32 m0, s59, 162736
    s_mov_b64 exec, 1
    buffer_load_dword v232, s[40:43], 0 offen sc1 lds
    s_mov_b64 exec, -1
    s_add_u32 m0, s64, 98304
    s_add_u32 s3, s61, 2048
    buffer_load_dwordx4 v2, s[36:39], s3 offen  sc1 lds
    buffer_load_dwordx4 v2, s[36:39], s3 offen offset:1024 sc1 lds
    buffer_load_dwordx4 v2, s[36:39], s3 offen offset:2048 sc1 lds
    buffer_load_dwordx4 v2, s[36:39], s3 offen offset:3072 sc1 lds
    s_add_u32 m0, s59, 162752
    s_mov_b64 exec, 1
    buffer_load_dword v232, s[40:43], 0 offen sc1 lds
    s_mov_b64 exec, -1
XSPEC:
    s_and_b32 s3, s44, 1
    s_mul_i32 s3, s3, 114688
    s_cmp_eq_u32 s44, 2
    s_cselect_b32 s3, 14336, s3
    s_sub_u32 s61, s61, s3
    s_sub_u32 s62, s62, s3
    s_sub_u32 s63, s63, s3
    s_mov_b32 s59, 0
    s_cmp_ge_u32 s44, 2
    s_cbranch_scc1 XL2
    s_cmp_eq_u32 s44, 1
    s_cbranch_scc1 XL1
    s_cmp_ge_u32 s67, 2
    s_cbranch_scc1 SWD_76
SW_75:
    ds_read_b128 v[228:231], v233
    s_sub_u32 s66, s66, 1
    s_cbranch_scc1 END_X
    s_waitcnt lgkmcnt(0)
    v_min3_u32 v228, v228, v229, v230
    v_min_u32 v228, v228, v231
    s_nop 0
    v_readfirstlane_b32 s67, v228
    s_nop 0
    s_cmp_ge_u32 s67, 2
    s_cbranch_scc1 SWD_76
    s_sleep 1
    s_branch SW_75
SWD_76:
    s_add_u32 m0, s59, 32768
    s_add_u32 s3, s61, 6144
    buffer_load_dwordx4 v2, s[36:39], s3 offen  sc1 lds
    buffer_load_dwordx4 v2, s[36:39], s3 offen offset:1024 sc1 lds
    buffer_load_dwordx4 v2, s[36:39], s3 offen offset:2048 sc1 lds
    buffer_load_dwordx4 v2, s[36:39], s3 offen offset:3072 sc1 lds
    s_add_u32 m0, s59, 36864
    s_add_u32 s3, s61, 120832
    buffer_load_dwordx4 v2, s[36:39], s3 offen  sc1 lds
    buffer_load_dwordx4 v2, s[36:39], s3 offen offset:1024 sc1 lds
    buffer_load_dwordx4 v2, s[36:39], s3 offen offset:2048 sc1 lds
    buffer_load_dwordx4 v2, s[36:39], s3 offen offset:3072 sc1 lds
    s_add_u32 m0, s59, 40960
    s_add_u32 s3, s61, 20480
    buffer_load_dwordx4 v2, s[36:39], s3 offen  sc1 lds
    buffer_load_dwordx4 v2, s[36:39], s3 offen offset:1024 sc1 lds
    buffer_load_dwordx4 v2, s[36:39], s3 offen offset:2048 sc1 lds
    buffer_load_dwordx4 v2, s[36:39], s3 offen offset:3072 sc1 lds
    s_add_u32 m0, s59, 45056
    s_add_u32 s3, s61, 135168
    buffer_load_dwordx4 v2, s[36:39], s3 offen  sc1 lds
    buffer_load_dwordx4 v2, s[36:39], s3 offen offset:1024 sc1 lds
    buffer_load_dwordx4 v2, s[36:39], s3 offen offset:2048 sc1 lds
    buffer_load_dwordx4 v2, s[36:39], s3 offen offset:3072 sc1 lds
    s_add_u32 m0, s59, 162768
    s_mov_b64 exec, 15
    buffer_load_dword v232, s[40:43], 0 offen sc1 lds
    s_mov_b64 exec, -1
    s_add_u32 m0, s59, 49152
    s_add_u32 s3, s61, 10240
    buffer_load_dwordx4 v2, s[36:39], s3 offen  sc1 lds
    buffer_load_dwordx4 v2, s[36:39], s3 offen offset:1024 sc1 lds
    buffer_load_dwordx4 v2, s[36:39], s3 offen offset:2048 sc1 lds
    buffer_load_dwordx4 v2, s[36:39], s3 offen offset:3072 sc1 lds
    s_add_u32 m0, s59, 53248
    s_add_u32 s3, s61, 124928
    buffer_load_dwordx4 v2, s[36:39], s3 offen  sc1 lds
    buffer_load_dwordx4 v2, s[36:39], s3 offen offset:1024 sc1 lds
    buffer_load_dwordx4 v2, s[36:39], s3 offen offset:2048 sc1 lds
    buffer_load_dwordx4 v2, s[36:39], s3 offen offset:3072 sc1 lds
    s_add_u32 m0, s59, 57344
    s_add_u32 s3, s61, 24576
    buffer_load_dwordx4 v2, s[36:39], s3 offen  sc1 lds
    buffer_load_dwordx4 v2, s[36:39], s3 offen offset:1024 sc1 lds
    buffer_load_dwordx4 v2, s[36:39], s3 offen offset:2048 sc1 lds
    buffer_load_dwordx4 v2, s[36:39], s3 offen offset:3072 sc1 lds
    s_add_u32 m0, s59, 61440
    s_add_u32 s3, s61, 139264
    buffer_load_dwordx4 v2, s[36:39], s3 offen  sc1 lds
    buffer_load_dwordx4 v2, s[36:39], s3 offen offset:1024 sc1 lds
    buffer_load_dwordx4 v2, s[36:39], s3 offen offset:2048 sc1 lds
    buffer_load_dwordx4 v2, s[36:39], s3 offen offset:3072 sc1 lds
    s_add_u32 m0, s59, 162784
    s_mov_b64 exec, 15
    buffer_load_dword v232, s[40:43], 0 offen sc1 lds
    s_mov_b64 exec, -1
    s_branch END_X
XL1:
    s_mov_b64 s[70:71], 0
    s_sub_u32 s6, s52, 2
    s_and_b32 s6, s6, 3
    s_mul_i32 s6, s6, 7
    s_lshl_b32 s6, 0x7f, s6
    s_or_b32 s70, s70, s6
    s_mov_b64 exec, s[70:71]
    s_mov_b32 s5, 0
POLL_77:
    buffer_load_dword v224, v7, s[36:39], s65 offen sc1
    s_waitcnt vmcnt(0)
    v_cmp_eq_u32 s[76:77], s47, v224
    s_add_u32 s5, s5, 1
    s_cmp_gt_u32 s5, 40000
    s_cbranch_scc1 POLLD_78
    s_andn2_b64 s[6:7], s[70:71], s[76:77]
    s_cbranch_scc1 POLL_77
POLLD_78:
    s_mov_b64 exec, -1
    s_cmp_ge_u32 s67, 2
    s_cbranch_scc1 SWD_80
SW_79:
    ds_read_b128 v[228:231], v233
    s_sub_u32 s66, s66, 1
    s_cbranch_scc1 END_X
    s_waitcnt lgkmcnt(0)
    v_min3_u32 v228, v228, v229, v230
    v_min_u32 v228, v228, v231
    s_nop 0
    v_readfirstlane_b32 s67, v228
    s_nop 0
    s_cmp_ge_u32 s67, 2
    s_cbranch_scc1 SWD_80
    s_sleep 1
    s_branch SW_79
SWD_80:
    s_add_u32 m0, s59, 122880
    s_add_u32 s3, s62, 0
    buffer_load_dwordx4 v2, s[36:39], s3 offen  sc1 lds
    buffer_load_dwordx4 v2, s[36:39], s3 offen offset:1024 sc1 lds
    buffer_load_dwordx4 v2, s[36:39], s3 offen offset:2048 sc1 lds
    buffer_load_dwordx4 v2, s[36:39], s3 offen offset:3072 sc1 lds
    s_add_u32 m0, s59, 126976
    s_add_u32 s3, s62, 114688
    buffer_load_dwordx4 v2, s[36:39], s3 offen  sc1 lds
    buffer_load_dwordx4 v2, s[36:39], s3 offen offset:1024 sc1 lds
    buffer_load_dwordx4 v2, s[36:39], s3 offen offset:2048 sc1 lds
    buffer_load_dwordx4 v2, s[36:39], s3 offen offset:3072 sc1 lds
    s_add_u32 m0, s59, 131072
    s_add_u32 s3, s62, 14336
    buffer_load_dwordx4 v2, s[36:39], s3 offen  sc1 lds
    buffer_load_dwordx4 v2, s[36:39], s3 offen offset:1024 sc1 lds
    buffer_load_dwordx4 v2, s[36:39], s3 offen offset:2048 sc1 lds
    buffer_load_dwordx4 v2, s[36:39], s3 offen offset:3072 sc1 lds
    s_add_u32 m0, s59, 135168
    s_add_u32 s3, s62, 129024
    buffer_load_dwordx4 v2, s[36:39], s3 offen  sc1 lds
    buffer_load_dwordx4 v2, s[36:39], s3 offen offset:1024 sc1 lds
    buffer_load_dwordx4 v2, s[36:39], s3 offen offset:2048 sc1 lds
    buffer_load_dwordx4 v2, s[36:39], s3 offen offset:3072 sc1 lds
    s_add_u32 m0, s59, 162800
    s_mov_b64 exec, 15
    buffer_load_dword v232, s[40:43], 0 offen sc1 lds
    s_mov_b64 exec, -1
    s_cmp_ge_u32 s67, 3
    s_cbranch_scc1 SWD_82
SW_81:
    ds_read_b128 v[228:231], v233
    s_sub_u32 s66, s66, 1
    s_cbranch_scc1 END_X
    s_waitcnt lgkmcnt(0)
    v_min3_u32 v228, v228, v229, v230
    v_min_u32 v228, v228, v231
    s_nop 0
    v_readfirstlane_b32 s67, v228
    s_nop 0
    s_cmp_ge_u32 s67, 3
    s_cbranch_scc1 SWD_82
    s_sleep 1
    s_branch SW_81
SWD_82:
    s_add_u32 m0, s59, 65536
    s_add_u32 s3, s62, 4096
    buffer_load_dwordx4 v2, s[36:39], s3 offen  sc1 lds
    buffer_load_dwordx4 v2, s[36:39], s3 offen offset:1024 sc1 lds
    buffer_load_dwordx4 v2, s[36:39], s3 offen offset:2048 sc1 lds
    buffer_load_dwordx4 v2, s[36:39], s3 offen offset:3072 sc1 lds
    s_add_u32 m0, s59, 69632
    s_add_u32 s3, s62, 118784
    buffer_load_dwordx4 v2, s[36:39], s3 offen  sc1 lds
    buffer_load_dwordx4 v2, s[36:39], s3 offen offset:1024 sc1 lds
    buffer_load_dwordx4 v2, s[36:39], s3 offen offset:2048 sc1 lds
    buffer_load_dwordx4 v2, s[36:39], s3 offen offset:3072 sc1 lds
    s_add_u32 m0, s59, 73728
    s_add_u32 s3, s62, 18432
    buffer_load_dwordx4 v2, s[36:39], s3 offen  sc1 lds
    buffer_load_dwordx4 v2, s[36:39], s3 offen offset:1024 sc1 lds
    buffer_load_dwordx4 v2, s[36:39], s3 offen offset:2048 sc1 lds
    buffer_load_dwordx4 v2, s[36:39], s3 offen offset:3072 sc1 lds
    s_add_u32 m0, s59, 77824
    s_add_u32 s3, s62, 133120
    buffer_load_dwordx4 v2, s[36:39], s3 offen  sc1 lds
    buffer_load_dwordx4 v2, s[36:39], s3 offen offset:1024 sc1 lds
    buffer_load_dwordx4 v2, s[36:39], s3 offen offset:2048 sc1 lds
    buffer_load_dwordx4 v2, s[36:39], s3 offen offset:3072 sc1 lds
    s_add_u32 m0, s59, 163200
    s_mov_b64 exec, 15
    buffer_load_dword v232, s[40:43], 0 offen sc1 lds
    s_mov_b64 exec, -1
    s_cmp_ge_u32 s67, 3
    s_cbranch_scc1 SWD_84
SW_83:
    ds_read_b128 v[228:231], v233
    s_sub_u32 s66, s66, 1
    s_cbranch_scc1 END_X
    s_waitcnt lgkmcnt(0)
    v_min3_u32 v228, v228, v229, v230
    v_min_u32 v228, v228, v231
    s_nop 0
    v_readfirstlane_b32 s67, v228
    s_nop 0
    s_cmp_ge_u32 s67, 3
    s_cbranch_scc1 SWD_84
    s_sleep 1
    s_branch SW_83
SWD_84:
    s_add_u32 m0, s59, 139264
    s_add_u32 s3, s62, 8192
    buffer_load_dwordx4 v2, s[36:39], s3 offen  sc1 lds
    buffer_load_dwordx4 v2, s[36:39], s3 offen offset:1024 sc1 lds
    buffer_load_dwordx4 v2, s[36:39], s3 offen offset:2048 sc1 lds
    buffer_load_dwordx4 v2, s[36:39], s3 offen offset:3072 sc1 lds
    s_add_u32 m0, s59, 143360
    s_add_u32 s3, s62, 122880
    buffer_load_dwordx4 v2, s[36:39], s3 offen  sc1 lds
    buffer_load_dwordx4 v2, s[36:39], s3 offen offset:1024 sc1 lds
    buffer_load_dwordx4 v2, s[36:39], s3 offen offset:2048 sc1 lds
    buffer_load_dwordx4 v2, s[36:39], s3 offen offset:3072 sc1 lds
    s_add_u32 m0, s59, 147456
    s_add_u32 s3, s62, 22528
    buffer_load_dwordx4 v2, s[36:39], s3 offen  sc1 lds
    buffer_load_dwordx4 v2, s[36:39], s3 offen offset:1024 sc1 lds
    buffer_load_dwordx4 v2, s[36:39], s3 offen offset:2048 sc1 lds
    buffer_load_dwordx4 v2, s[36:39], s3 offen offset:3072 sc1 lds
    s_add_u32 m0, s59, 151552
    s_add_u32 s3, s62, 137216
    buffer_load_dwordx4 v2, s[36:39], s3 offen  sc1 lds
    buffer_load_dwordx4 v2, s[36:39], s3 offen offset:1024 sc1 lds
    buffer_load_dwordx4 v2, s[36:39], s3 offen offset:2048 sc1 lds
    buffer_load_dwordx4 v2, s[36:39], s3 offen offset:3072 sc1 lds
    s_add_u32 m0, s59, 163216
    s_mov_b64 exec, 15
    buffer_load_dword v232, s[40:43], 0 offen sc1 lds
    s_mov_b64 exec, -1
    s_branch END_X
XL2:
    s_and_b32 s56, s44, 1
    s_lshl_b32 s57, s56, 3
    s_waitcnt vmcnt(0)
    v_add_f32 v28, v28, v32
    v_add_f32 v36, v36, v40
    v_add_f32 v30, v30, v34
    v_add_f32 v38, v38, v42
    v_add_f32 v29, v29, v33
    v_add_f32 v37, v37, v41
    v_add_f32 v31, v31, v35
    v_add_f32 v39, v39, v43
    v_permlane32_swap_b32 v28, v30
    v_permlane32_swap_b32 v36, v38
    v_permlane32_swap_b32 v29, v31
    v_permlane32_swap_b32 v37, v39
    v_add_f32 v28, v28, v30
    v_add_f32 v36, v36, v38
    v_add_f32 v29, v29, v31
    v_add_f32 v37, v37, v39
    s_nop 0
    v_permlane16_swap_b32 v28, v29
    v_permlane16_swap_b32 v36, v37
    v_add_f32 v28, v28, v29
    v_add_f32 v36, v36, v37
    s_nop 0
    v_add_f32_dpp v28, v28, v28 row_ror:8 row_mask:0xf bank_mask:0xf
    v_add_f32_dpp v36, v36, v36 row_ror:8 row_mask:0xf bank_mask:0xf
    v_mul_f32 v28, 0x3b124925, v28
    v_mul_f32 v36, 0x3b124925, v36
    v_and_b32 v32, 7, v1
    v_lshrrev_b32 v33, 5, v1
    v_bfe_u32 v34, v1, 4, 1
    v_fma_f32 v36, -v28, v28, v36
    v_lshlrev_b32 v32, 4, v32
    v_max_f32 v36, 0, v36
    v_lshl_add_u32 v32, v33, 3, v32
    v_add_f32 v36, 0x3727c5ac, v36
    v_lshl_add_u32 v32, v34, 2, v32
    v_rcp_f32 v44, v36
    s_lshl_b32 s3, s56, 8
    s_add_u32 s3, s3, 155648
    v_add_u32 v45, s3, v32
    s_lshl_b32 s56, s56, 13
    s_mov_b64 s[70:71], 0
    s_sub_u32 s6, s52, 2
    s_and_b32 s6, s6, 3
    s_mul_i32 s6, s6, 7
    s_lshl_b32 s6, 0x7f, s6
    s_or_b32 s70, s70, s6
    s_sub_u32 s6, s52, 3
    s_and_b32 s6, s6, 3
    s_mul_i32 s6, s6, 7
    s_lshl_b32 s6, 0x7f, s6
    s_or_b32 s70, s70, s6
    s_mov_b64 exec, s[70:71]
    s_mov_b32 s5, 0
POLL_85:
    buffer_load_dword v224, v7, s[36:39], s65 offen sc1
    s_waitcnt vmcnt(0)
    v_cmp_eq_u32 s[76:77], s47, v224
    s_add_u32 s5, s5, 1
    s_cmp_gt_u32 s5, 40000
    s_cbranch_scc1 POLLD_86
    s_andn2_b64 s[6:7], s[70:71], s[76:77]
    s_cbranch_scc1 POLL_85
POLLD_86:
    s_mov_b64 exec, -1
    s_cmp_ge_u32 s67, 4
    s_cbranch_scc1 SWD_88
SW_87:
    ds_read_b128 v[228:231], v233
    s_sub_u32 s66, s66, 1
    s_cbranch_scc1 END_X
    s_waitcnt lgkmcnt(0)
    v_min3_u32 v228, v228, v229, v230
    v_min_u32 v228, v228, v231
    s_nop 0
    v_readfirstlane_b32 s67, v228
    s_nop 0
    s_cmp_ge_u32 s67, 4
    s_cbranch_scc1 SWD_88
    s_sleep 1
    s_branch SW_87
SWD_88:
    s_add_u32 m0, s56, 81920
    s_add_u32 s3, s62, 12288
    buffer_load_dwordx4 v2, s[36:39], s3 offen  sc1 lds
    buffer_load_dwordx4 v2, s[36:39], s3 offen offset:1024 sc1 lds
    s_sub_u32 s3, s63, 2048
    buffer_load_dwordx4 v2, s[36:39], s3 offen offset:2048 sc1 lds
    buffer_load_dwordx4 v2, s[36:39], s3 offen offset:3072 sc1 lds
    s_add_u32 m0, s56, 86016
    s_add_u32 s3, s62, 126976
    buffer_load_dwordx4 v2, s[36:39], s3 offen  sc1 lds
    buffer_load_dwordx4 v2, s[36:39], s3 offen offset:1024 sc1 lds
    s_add_u32 s3, s63, 112640
    buffer_load_dwordx4 v2, s[36:39], s3 offen offset:2048 sc1 lds
    buffer_load_dwordx4 v2, s[36:39], s3 offen offset:3072 sc1 lds
    s_add_u32 m0, s57, 163232
    s_mov_b64 exec, 3
    buffer_load_dword v232, s[40:43], 0 offen sc1 lds
    s_mov_b64 exec, -1
    s_cmp_ge_u32 s67, 4
    s_cbranch_scc1 SWD_90
SW_89:
    ds_read_b128 v[228:231], v233
    s_sub_u32 s66, s66, 1
    s_cbranch_scc1 END_X
    s_waitcnt lgkmcnt(0)
    v_min3_u32 v228, v228, v229, v230
    v_min_u32 v228, v228, v231
    s_nop 0
    v_readfirstlane_b32 s67, v228
    s_nop 0
    s_cmp_ge_u32 s67, 4
    s_cbranch_scc1 SWD_90
    s_sleep 1
    s_branch SW_89
SWD_90:
    s_add_u32 m0, s56, 0
    s_add_u32 s3, s63, 2048
    buffer_load_dwordx4 v2, s[36:39], s3 offen  sc1 lds
    buffer_load_dwordx4 v2, s[36:39], s3 offen offset:1024 sc1 lds
    buffer_load_dwordx4 v2, s[36:39], s3 offen offset:2048 sc1 lds
    buffer_load_dwordx4 v2, s[36:39], s3 offen offset:3072 sc1 lds
    s_add_u32 m0, s56, 4096
    s_add_u32 s3, s63, 116736
    buffer_load_dwordx4 v2, s[36:39], s3 offen  sc1 lds
    buffer_load_dwordx4 v2, s[36:39], s3 offen offset:1024 sc1 lds
    buffer_load_dwordx4 v2, s[36:39], s3 offen offset:2048 sc1 lds
    buffer_load_dwordx4 v2, s[36:39], s3 offen offset:3072 sc1 lds
    s_add_u32 m0, s57, 163248
    s_mov_b64 exec, 3
    buffer_load_dword v232, s[40:43], 0 offen sc1 lds
    s_mov_b64 exec, -1
    s_cmp_ge_u32 s67, 5
    s_cbranch_scc1 SWD_92
SW_91:
    ds_read_b128 v[228:231], v233
    s_sub_u32 s66, s66, 1
    s_cbranch_scc1 END_X
    s_waitcnt lgkmcnt(0)
    v_min3_u32 v228, v228, v229, v230
    v_min_u32 v228, v228, v231
    s_nop 0
    v_readfirstlane_b32 s67, v228
    s_nop 0
    s_cmp_ge_u32 s67, 5
    s_cbranch_scc1 SWD_92
    s_sleep 1
    s_branch SW_91
SWD_92:
    s_add_u32 m0, s56, 98304
    s_add_u32 s3, s63, 6144
    buffer_load_dwordx4 v2, s[36:39], s3 offen  sc1 lds
    buffer_load_dwordx4 v2, s[36:39], s3 offen offset:1024 sc1 lds
    buffer_load_dwordx4 v2, s[36:39], s3 offen offset:2048 sc1 lds
    buffer_load_dwordx4 v2, s[36:39], s3 offen offset:3072 sc1 lds
    s_add_u32 m0, s56, 102400
    s_add_u32 s3, s63, 120832
    buffer_load_dwordx4 v2, s[36:39], s3 offen  sc1 lds
    buffer_load_dwordx4 v2, s[36:39], s3 offen offset:1024 sc1 lds
    buffer_load_dwordx4 v2, s[36:39], s3 offen offset:2048 sc1 lds
    buffer_load_dwordx4 v2, s[36:39], s3 offen offset:3072 sc1 lds
    s_add_u32 m0, s57, 163264
    s_mov_b64 exec, 3
    buffer_load_dword v232, s[40:43], 0 offen sc1 lds
    s_mov_b64 exec, -1
    s_cmp_ge_u32 s67, 6
    s_cbranch_scc1 SWD_94
SW_93:
    ds_read_b128 v[228:231], v233
    s_sub_u32 s66, s66, 1
    s_cbranch_scc1 END_X
    s_waitcnt lgkmcnt(0)
    v_min3_u32 v228, v228, v229, v230
    v_min_u32 v228, v228, v231
    s_nop 0
    v_readfirstlane_b32 s67, v228
    s_nop 0
    s_cmp_ge_u32 s67, 6
    s_cbranch_scc1 SWD_94
    s_sleep 1
    s_branch SW_93
SWD_94:
    s_add_u32 m0, s56, 16384
    s_add_u32 s3, s63, 10240
    buffer_load_dwordx4 v2, s[36:39], s3 offen  sc1 lds
    buffer_load_dwordx4 v2, s[36:39], s3 offen offset:1024 sc1 lds
    buffer_load_dwordx4 v2, s[36:39], s3 offen offset:2048 sc1 lds
    buffer_load_dwordx4 v2, s[36:39], s3 offen offset:3072 sc1 lds
    s_add_u32 m0, s56, 20480
    s_add_u32 s3, s63, 124928
    buffer_load_dwordx4 v2, s[36:39], s3 offen  sc1 lds
    buffer_load_dwordx4 v2, s[36:39], s3 offen offset:1024 sc1 lds
    buffer_load_dwordx4 v2, s[36:39], s3 offen offset:2048 sc1 lds
    buffer_load_dwordx4 v2, s[36:39], s3 offen offset:3072 sc1 lds
    s_add_u32 m0, s57, 163280
    s_mov_b64 exec, 3
    buffer_load_dword v232, s[40:43], 0 offen sc1 lds
    s_mov_b64 exec, -1
    s_waitcnt vmcnt(0)
    ds_write_b32 v45, v44
    s_waitcnt lgkmcnt(0)
END_X:
    s_waitcnt vmcnt(0) lgkmcnt(0)
    s_endpgm
EXIT:
    s_endpgm
KEND:
.section .rodata,"a"
.p2align 6
.amdhsa_kernel sequential_preLN__sliding_local_dilated__glu_gated_reglu__prompt_kernel
  .amdhsa_next_free_vgpr 256
  .amdhsa_next_free_sgpr 102
  .amdhsa_accum_offset 256
  .amdhsa_group_segment_fixed_size 0
  .amdhsa_kernarg_size 80
  .amdhsa_user_sgpr_count 2
  .amdhsa_user_sgpr_kernarg_segment_ptr 1
  .amdhsa_system_sgpr_workgroup_id_x 1
.end_amdhsa_kernel
```
